```python
import torch

def _softmax(x, axis=-1):
    return torch.softmax(x, dim=axis)
def _gelu(x):
    return torch.nn.functional.gelu(x, approximate="tanh")
def _silu(x):
    return torch.nn.functional.silu(x)
def _sigmoid(x):
    return torch.sigmoid(x)
def _layernorm(x, axis=-1, eps=1e-5):
    m = x.mean(dim=axis, keepdim=True)
    v = x.var(dim=axis, keepdim=True, unbiased=False)
    return (x - m) / torch.sqrt(v + eps)
def _scatter_add(tgt, idx, src, axis=0):
    return tgt.clone().index_add_(axis, idx, src)
def _segment_sum(src, seg, n):
    out = torch.zeros((n,) + src.shape[1:], dtype=src.dtype)
    return out.index_add_(0, seg, src)
def _pad(x, pw):
    flat = tuple(v for pair in reversed(pw) for v in pair)
    return torch.nn.functional.pad(x, flat)

kernel_name = 'sequential_preLN__mha_block_cached__glu_gated_glu__decode'

def setup_inputs():

    _w = (lambda a: (lambda t: t.to(torch.bfloat16) if t.is_floating_point() else t)(torch.as_tensor(a)))
    def _A_setup():
        B, Sq, D = 1, 1, 640
        H, Sk, Dh = 32, 32768, 192
        return {
            "x": _w((lambda *s: torch.randn(*s, dtype=torch.bfloat16) * 0.05)(B, Sq, D)),
            "k_cache": _w((lambda *s: torch.randn(*s, dtype=torch.bfloat16) * 3.2)(B, H, Sk, Dh)),
            "v_cache": _w((lambda *s: torch.randn(*s, dtype=torch.bfloat16) * 0.4)(B, H, Sk, Dh)),
            "wq": _w((lambda *s: torch.randn(*s, dtype=torch.bfloat16) * 3.2)(D, H * Dh) * (D ** -0.5)),
            "wo": _w((lambda *s: torch.randn(*s, dtype=torch.bfloat16) * 0.4)(H * Dh, D) * ((H * Dh) ** -0.5)),
        }
    _A_in = _A_setup()

    def _B_setup():
        B, S, D, F = 1, 1, 640, 1536
        return {
            "x": _w((lambda *s: torch.randn(*s, dtype=torch.bfloat16) * 0.05)(B, S, D)),
            "w_gate": _w((lambda *s: torch.randn(*s, dtype=torch.bfloat16) * 0.1)(D, F)),
            "w_up": _w((lambda *s: torch.randn(*s, dtype=torch.bfloat16) * 0.05)(D, F)),
            "w_down": _w((lambda *s: torch.randn(*s, dtype=torch.bfloat16) * 0.05)(F, D)),
        }
    _B_in = _B_setup()

    return {
        "A_x": _A_in["x"],
        "A_k_cache": _A_in["k_cache"],
        "A_v_cache": _A_in["v_cache"],
        "A_wq": _A_in["wq"],
        "A_wo": _A_in["wo"],
        "B_x": _B_in["x"],
        "B_w_gate": _B_in["w_gate"],
        "B_w_up": _B_in["w_up"],
        "B_w_down": _B_in["w_down"],
    }

def reference(A_x, A_k_cache, A_v_cache, A_wq, A_wo, B_x, B_w_gate, B_w_up, B_w_down):
    def _A_ref(x, k_cache, v_cache, wq, wo):
        B, Sq, D = x.shape
        H, Dh = 32, 192
        q = (lambda x, *d: x.permute(*d))((x @ wq).reshape(B, Sq, H, Dh), 0, 2, 1, 3)
        scores = torch.einsum("bhqd,bhkd->bhqk", q, k_cache) * (Dh ** -0.5)
        p = _softmax(scores, axis=-1)
        o = torch.einsum("bhqk,bhkd->bhqd", p, v_cache)
        return (lambda x, *d: x.permute(*d))(o, 0, 2, 1, 3).reshape(B, Sq, H * Dh) @ wo

    def _B_ref(x, w_gate, w_up, w_down):
        g = torch.einsum("bsd,df->bsf", x, w_gate)
        u = torch.einsum("bsd,df->bsf", x, w_up)
        h = _sigmoid(g) * u
        return torch.einsum("bsf,fd->bsd", h, w_down)

    x = A_x
    h = x + _A_ref(_layernorm(x, axis=-1), A_k_cache, A_v_cache, A_wq, A_wo)
    h2 = h + _B_ref(_layernorm(h, axis=-1), B_w_gate, B_w_up, B_w_down)
    return h2
```

```asm
; @launch grid=(256,1,1) block=(512,1,1) lds=126784
.amdgcn_target "amdgcn-amd-amdhsa--gfx950"
.text
.globl sequential_preLN__mha_block_cached__glu_gated_glu__decode_kernel
.p2align 8
.type sequential_preLN__mha_block_cached__glu_gated_glu__decode_kernel,@function
sequential_preLN__mha_block_cached__glu_gated_glu__decode_kernel:
  s_cmp_ge_u32 s2, 256
  s_cbranch_scc1 L_end
  s_load_dwordx16 s[16:31], s[0:1], 0
  s_load_dwordx8 s[32:39], s[0:1], 64
  v_lshrrev_b32 v1, 6, v0
  v_and_b32 v2, 63, v0
  s_lshr_b32 s60, s2, 3
  v_readfirstlane_b32 s3, v1
  s_and_b32 s61, s2, 7
  s_cmp_ge_u32 s3, 4
  s_cbranch_scc1 L_helper
  s_mul_i32 s62, s60, 12582912
  s_lshl_b32 s63, s61, 2
  s_add_u32 s63, s63, s3
  s_mul_i32 s63, s63, 12288
  v_mul_u32_u24 v3, 12, v2
  v_add_u32 v4, 4608, v3
  v_add_u32 v5, 9216, v3
  s_lshl_b32 s64, s60, 8
  s_add_u32 s64, s64, 32768
  s_waitcnt lgkmcnt(0)
  s_add_u32 s4, s18, s62
  s_addc_u32 s5, s19, 0
  s_mov_b32 s6, 12582912
  s_mov_b32 s7, 0x20000
  s_add_u32 s8, s20, s62
  s_addc_u32 s9, s21, 0
  s_mov_b32 s10, 12582912
  s_mov_b32 s11, 0x20000
  s_add_u32 s92, s38, s64
  s_addc_u32 s93, s39, 0
  s_barrier
  buffer_load_dwordx3 v[128:130], v3, s[4:7], s63 offen offset:0 nt
  buffer_load_dwordx3 v[132:134], v3, s[4:7], s63 offen offset:768 nt
  buffer_load_dwordx3 v[136:138], v3, s[4:7], s63 offen offset:1536 nt
  buffer_load_dwordx3 v[140:142], v3, s[4:7], s63 offen offset:2304 nt
  buffer_load_dwordx3 v[144:146], v3, s[4:7], s63 offen offset:3072 nt
  buffer_load_dwordx3 v[148:150], v3, s[4:7], s63 offen offset:3840 nt
  buffer_load_dwordx3 v[152:154], v4, s[4:7], s63 offen offset:0 nt
  buffer_load_dwordx3 v[156:158], v4, s[4:7], s63 offen offset:768 nt
  buffer_load_dwordx3 v[160:162], v4, s[4:7], s63 offen offset:1536 nt
  buffer_load_dwordx3 v[164:166], v4, s[4:7], s63 offen offset:2304 nt
  buffer_load_dwordx3 v[168:170], v4, s[4:7], s63 offen offset:3072 nt
  buffer_load_dwordx3 v[172:174], v4, s[4:7], s63 offen offset:3840 nt
  buffer_load_dwordx3 v[176:178], v5, s[4:7], s63 offen offset:0 nt
  buffer_load_dwordx3 v[180:182], v5, s[4:7], s63 offen offset:768 nt
  buffer_load_dwordx3 v[184:186], v5, s[4:7], s63 offen offset:1536 nt
  buffer_load_dwordx3 v[188:190], v5, s[4:7], s63 offen offset:2304 nt
  buffer_load_dwordx3 v[192:194], v3, s[8:11], s63 offen offset:0 nt
  buffer_load_dwordx3 v[196:198], v3, s[8:11], s63 offen offset:768 nt
  buffer_load_dwordx3 v[200:202], v3, s[8:11], s63 offen offset:1536 nt
  buffer_load_dwordx3 v[204:206], v3, s[8:11], s63 offen offset:2304 nt
  buffer_load_dwordx3 v[208:210], v3, s[8:11], s63 offen offset:3072 nt
  buffer_load_dwordx3 v[212:214], v3, s[8:11], s63 offen offset:3840 nt
  buffer_load_dwordx3 v[216:218], v4, s[8:11], s63 offen offset:0 nt
  buffer_load_dwordx3 v[220:222], v4, s[8:11], s63 offen offset:768 nt
  buffer_load_dwordx3 v[224:226], v4, s[8:11], s63 offen offset:1536 nt
  buffer_load_dwordx3 v[228:230], v4, s[8:11], s63 offen offset:2304 nt
  buffer_load_dwordx3 v[232:234], v4, s[8:11], s63 offen offset:3072 nt
  buffer_load_dwordx3 v[236:238], v4, s[8:11], s63 offen offset:3840 nt
  buffer_load_dwordx3 v[240:242], v5, s[8:11], s63 offen offset:0 nt
  buffer_load_dwordx3 v[244:246], v5, s[8:11], s63 offen offset:768 nt
  buffer_load_dwordx3 v[248:250], v5, s[8:11], s63 offen offset:1536 nt
  buffer_load_dwordx3 v[252:254], v5, s[8:11], s63 offen offset:2304 nt
  v_bfe_u32 v21, v2, 4, 1
  v_bfe_u32 v22, v2, 3, 1
  v_lshl_add_u32 v21, v22, 1, v21
  v_bfe_u32 v22, v2, 2, 1
  v_lshl_add_u32 v21, v22, 2, v21
  v_bfe_u32 v22, v2, 1, 1
  v_lshl_add_u32 v21, v22, 3, v21
  v_lshlrev_b32 v21, 3, v21
  v_and_b32 v22, 1, v2
  v_lshl_add_u32 v21, v22, 2, v21
  v_lshrrev_b32 v23, 5, v2
  v_lshlrev_b32 v23, 7, v23
  s_lshl_b32 s64, s3, 8
  s_add_u32 s64, s64, 11264
  v_add_u32 v19, s64, v23
  v_add_u32 v18, v19, v21
  v_mov_b32 v23, 0xffff
  v_mov_b32 v24, 0xffff0000
  v_cmp_eq_u32 vcc, 1, v22
  s_mov_b32 s66, 0xcccccccc
  s_mov_b32 s67, 0xcccccccc
  v_cndmask_b32 v20, v23, v24, vcc
  v_mov_b32 v9, 0xff800000
  v_mov_b32 v10, 0
  v_mov_b32 v12, 0
  v_mov_b32 v13, 0
  v_mov_b32 v14, 0
  v_mov_b32 v15, 0
  v_mov_b32 v16, 0
  v_mov_b32 v17, 0
  v_and_b32 v11, 31, v2
  v_mul_u32_u24 v11, 24, v11
  v_mov_b32 v26, 0
  v_mov_b32 v27, 1
  s_mov_b32 s65, 25
  s_mov_b32 s50, 0
  s_mov_b32 s68, 0x3d93cd3a
  s_mov_b32 s69, 0x3fb8aa3b
  s_barrier
  ds_read_b64 v[32:33], v11 offset:5120
  ds_read_b64 v[34:35], v11 offset:5128
  ds_read_b64 v[36:37], v11 offset:5136
  ds_read_b64 v[38:39], v11 offset:5888
  ds_read_b64 v[40:41], v11 offset:5896
  ds_read_b64 v[42:43], v11 offset:5904
  ds_read_b64 v[44:45], v11 offset:6656
  ds_read_b64 v[46:47], v11 offset:6664
  ds_read_b64 v[48:49], v11 offset:6672
  ds_read_b64 v[50:51], v11 offset:7424
  ds_read_b64 v[52:53], v11 offset:7432
  ds_read_b64 v[54:55], v11 offset:7440
  ds_read_b64 v[56:57], v11 offset:8192
  ds_read_b64 v[58:59], v11 offset:8200
  ds_read_b64 v[60:61], v11 offset:8208
  ds_read_b64 v[62:63], v11 offset:8960
  ds_read_b64 v[64:65], v11 offset:8968
  ds_read_b64 v[66:67], v11 offset:8976
  ds_read_b64 v[68:69], v11 offset:9728
  ds_read_b64 v[70:71], v11 offset:9736
  ds_read_b64 v[72:73], v11 offset:9744
  ds_read_b64 v[74:75], v11 offset:10496
  ds_read_b64 v[76:77], v11 offset:10504
  ds_read_b64 v[78:79], v11 offset:10512
  s_waitcnt lgkmcnt(0)
  v_add_f32 v32, v32, v38
  v_add_f32 v33, v33, v39
  v_add_f32 v34, v34, v40
  v_add_f32 v35, v35, v41
  v_add_f32 v36, v36, v42
  v_add_f32 v37, v37, v43
  v_add_f32 v44, v44, v50
  v_add_f32 v45, v45, v51
  v_add_f32 v46, v46, v52
  v_add_f32 v47, v47, v53
  v_add_f32 v48, v48, v54
  v_add_f32 v49, v49, v55
  v_add_f32 v56, v56, v62
  v_add_f32 v57, v57, v63
  v_add_f32 v58, v58, v64
  v_add_f32 v59, v59, v65
  v_add_f32 v60, v60, v66
  v_add_f32 v61, v61, v67
  v_add_f32 v68, v68, v74
  v_add_f32 v69, v69, v75
  v_add_f32 v70, v70, v76
  v_add_f32 v71, v71, v77
  v_add_f32 v72, v72, v78
  v_add_f32 v73, v73, v79
  v_add_f32 v32, v32, v44
  v_add_f32 v33, v33, v45
  v_add_f32 v34, v34, v46
  v_add_f32 v35, v35, v47
  v_add_f32 v36, v36, v48
  v_add_f32 v37, v37, v49
  v_add_f32 v56, v56, v68
  v_add_f32 v57, v57, v69
  v_add_f32 v58, v58, v70
  v_add_f32 v59, v59, v71
  v_add_f32 v60, v60, v72
  v_add_f32 v61, v61, v73
  v_add_f32 v32, v32, v56
  v_add_f32 v33, v33, v57
  v_add_f32 v34, v34, v58
  v_add_f32 v35, v35, v59
  v_add_f32 v36, v36, v60
  v_add_f32 v37, v37, v61
  v_cvt_pk_bf16_f32 v6, v32, v33
  v_cvt_pk_bf16_f32 v7, v34, v35
  v_cvt_pk_bf16_f32 v8, v36, v37
L_loop:
  s_add_u32 s63, s63, 393216
  s_waitcnt vmcnt(31)
  v_dot2_f32_bf16 v32, v128, v6, 0
  v_dot2_f32_bf16 v32, v129, v7, v32
  v_dot2_f32_bf16 v32, v130, v8, v32
  buffer_load_dwordx3 v[128:130], v3, s[4:7], s63 offen offset:0 nt
  s_waitcnt vmcnt(31)
  v_dot2_f32_bf16 v33, v132, v6, 0
  v_dot2_f32_bf16 v33, v133, v7, v33
  v_dot2_f32_bf16 v33, v134, v8, v33
  buffer_load_dwordx3 v[132:134], v3, s[4:7], s63 offen offset:768 nt
  s_waitcnt vmcnt(31)
  v_dot2_f32_bf16 v34, v136, v6, 0
  v_dot2_f32_bf16 v34, v137, v7, v34
  v_dot2_f32_bf16 v34, v138, v8, v34
  buffer_load_dwordx3 v[136:138], v3, s[4:7], s63 offen offset:1536 nt
  s_waitcnt vmcnt(31)
  v_dot2_f32_bf16 v35, v140, v6, 0
  v_dot2_f32_bf16 v35, v141, v7, v35
  v_dot2_f32_bf16 v35, v142, v8, v35
  buffer_load_dwordx3 v[140:142], v3, s[4:7], s63 offen offset:2304 nt
  v_permlane16_swap_b32 v32, v33
  v_add_f32 v32, v32, v33
  s_waitcnt vmcnt(31)
  v_dot2_f32_bf16 v36, v144, v6, 0
  v_dot2_f32_bf16 v36, v145, v7, v36
  v_dot2_f32_bf16 v36, v146, v8, v36
  buffer_load_dwordx3 v[144:146], v3, s[4:7], s63 offen offset:3072 nt
  s_waitcnt vmcnt(31)
  v_dot2_f32_bf16 v37, v148, v6, 0
  v_dot2_f32_bf16 v37, v149, v7, v37
  v_dot2_f32_bf16 v37, v150, v8, v37
  buffer_load_dwordx3 v[148:150], v3, s[4:7], s63 offen offset:3840 nt
  v_permlane16_swap_b32 v34, v35
  v_add_f32 v34, v34, v35
  s_waitcnt vmcnt(31)
  v_dot2_f32_bf16 v38, v152, v6, 0
  v_dot2_f32_bf16 v38, v153, v7, v38
  v_dot2_f32_bf16 v38, v154, v8, v38
  buffer_load_dwordx3 v[152:154], v4, s[4:7], s63 offen offset:0 nt
  s_waitcnt vmcnt(31)
  v_dot2_f32_bf16 v39, v156, v6, 0
  v_dot2_f32_bf16 v39, v157, v7, v39
  v_dot2_f32_bf16 v39, v158, v8, v39
  buffer_load_dwordx3 v[156:158], v4, s[4:7], s63 offen offset:768 nt
  v_permlane16_swap_b32 v36, v37
  v_add_f32 v36, v36, v37
  s_waitcnt vmcnt(31)
  v_dot2_f32_bf16 v40, v160, v6, 0
  v_dot2_f32_bf16 v40, v161, v7, v40
  v_dot2_f32_bf16 v40, v162, v8, v40
  buffer_load_dwordx3 v[160:162], v4, s[4:7], s63 offen offset:1536 nt
  s_waitcnt vmcnt(31)
  v_dot2_f32_bf16 v41, v164, v6, 0
  v_dot2_f32_bf16 v41, v165, v7, v41
  v_dot2_f32_bf16 v41, v166, v8, v41
  buffer_load_dwordx3 v[164:166], v4, s[4:7], s63 offen offset:2304 nt
  v_permlane16_swap_b32 v38, v39
  v_add_f32 v38, v38, v39
  s_waitcnt vmcnt(31)
  v_dot2_f32_bf16 v42, v168, v6, 0
  v_dot2_f32_bf16 v42, v169, v7, v42
  v_dot2_f32_bf16 v42, v170, v8, v42
  buffer_load_dwordx3 v[168:170], v4, s[4:7], s63 offen offset:3072 nt
  s_waitcnt vmcnt(31)
  v_dot2_f32_bf16 v43, v172, v6, 0
  v_dot2_f32_bf16 v43, v173, v7, v43
  v_dot2_f32_bf16 v43, v174, v8, v43
  buffer_load_dwordx3 v[172:174], v4, s[4:7], s63 offen offset:3840 nt
  v_permlane16_swap_b32 v40, v41
  v_add_f32 v40, v40, v41
  s_waitcnt vmcnt(31)
  v_dot2_f32_bf16 v44, v176, v6, 0
  v_dot2_f32_bf16 v44, v177, v7, v44
  v_dot2_f32_bf16 v44, v178, v8, v44
  buffer_load_dwordx3 v[176:178], v5, s[4:7], s63 offen offset:0 nt
  s_waitcnt vmcnt(31)
  v_dot2_f32_bf16 v45, v180, v6, 0
  v_dot2_f32_bf16 v45, v181, v7, v45
  v_dot2_f32_bf16 v45, v182, v8, v45
  buffer_load_dwordx3 v[180:182], v5, s[4:7], s63 offen offset:768 nt
  v_permlane16_swap_b32 v42, v43
  v_add_f32 v42, v42, v43
  s_waitcnt vmcnt(31)
  v_dot2_f32_bf16 v46, v184, v6, 0
  v_dot2_f32_bf16 v46, v185, v7, v46
  v_dot2_f32_bf16 v46, v186, v8, v46
  buffer_load_dwordx3 v[184:186], v5, s[4:7], s63 offen offset:1536 nt
  s_waitcnt vmcnt(31)
  v_dot2_f32_bf16 v47, v188, v6, 0
  v_dot2_f32_bf16 v47, v189, v7, v47
  v_dot2_f32_bf16 v47, v190, v8, v47
  buffer_load_dwordx3 v[188:190], v5, s[4:7], s63 offen offset:2304 nt
  v_permlane16_swap_b32 v44, v45
  v_add_f32 v44, v44, v45
  s_nop 0
  v_permlane16_swap_b32 v46, v47
  v_add_f32 v46, v46, v47
  v_add_f32_dpp v32, v32, v32 row_ror:8 row_mask:0xf bank_mask:0x3
  v_add_f32_dpp v36, v36, v36 row_ror:8 row_mask:0xf bank_mask:0x3
  v_add_f32_dpp v40, v40, v40 row_ror:8 row_mask:0xf bank_mask:0x3
  v_add_f32_dpp v44, v44, v44 row_ror:8 row_mask:0xf bank_mask:0x3
  v_add_f32_dpp v32, v34, v34 row_ror:8 row_mask:0xf bank_mask:0xc
  v_add_f32_dpp v36, v38, v38 row_ror:8 row_mask:0xf bank_mask:0xc
  v_add_f32_dpp v40, v42, v42 row_ror:8 row_mask:0xf bank_mask:0xc
  v_add_f32_dpp v44, v46, v46 row_ror:8 row_mask:0xf bank_mask:0xc
  s_nop 0
  v_add_f32_dpp v32, v32, v32 row_half_mirror row_mask:0xf bank_mask:0x5
  v_add_f32_dpp v40, v40, v40 row_half_mirror row_mask:0xf bank_mask:0x5
  s_nop 0
  v_add_f32_dpp v32, v36, v36 row_half_mirror row_mask:0xf bank_mask:0xa
  v_add_f32_dpp v40, v44, v44 row_half_mirror row_mask:0xf bank_mask:0xa
  s_nop 1
  v_add_f32_dpp v33, v32, v32 quad_perm:[2,3,0,1] row_mask:0xf bank_mask:0xf
  v_add_f32_dpp v34, v40, v40 quad_perm:[2,3,0,1] row_mask:0xf bank_mask:0xf
  v_cndmask_b32 v32, v33, v34, s[66:67]
  s_nop 1
  v_add_f32_dpp v21, v32, v32 quad_perm:[1,0,3,2] row_mask:0xf bank_mask:0xf
  v_cvt_pk_bf16_f32 v21, v21, v21
  v_and_b32 v21, 0xffff0000, v21
  v_mul_f32 v21, s68, v21
  v_cvt_pk_bf16_f32 v21, v21, v21
  v_and_b32 v21, 0xffff0000, v21
  s_nop 1
  v_max_f32_dpp v22, v21, v21 row_ror:8 row_mask:0xf bank_mask:0xf
  s_nop 1
  v_max_f32_dpp v22, v22, v22 row_ror:4 row_mask:0xf bank_mask:0xf
  s_nop 1
  v_max_f32_dpp v22, v22, v22 row_ror:2 row_mask:0xf bank_mask:0xf
  v_mov_b32 v23, v22
  s_nop 1
  v_permlane16_swap_b32 v22, v23
  v_max_f32 v22, v22, v23
  v_mov_b32 v23, v22
  s_nop 1
  v_permlane32_swap_b32 v22, v23
  v_max_f32 v22, v22, v23
  v_cmp_gt_f32 vcc, v22, v9
  s_cbranch_vccz L_norss
  v_sub_f32 v23, v9, v22
  v_mul_f32 v23, s69, v23
  v_exp_f32 v23, v23
  v_mov_b32 v9, v22
  v_mul_f32 v12, v12, v23
  v_mul_f32 v13, v13, v23
  v_mul_f32 v14, v14, v23
  v_mul_f32 v15, v15, v23
  v_mul_f32 v16, v16, v23
  v_mul_f32 v17, v17, v23
  v_mul_f32 v10, v10, v23
L_norss:
  v_sub_f32 v21, v21, v9
  v_mul_f32 v21, s69, v21
  v_exp_f32 v21, v21
  s_nop 0
  v_cvt_pk_bf16_f32 v22, v21, v21
  v_add_f32 v10, v10, v21
  v_and_b32 v22, v22, v20
  ds_write_b32 v18, v22
  ds_read_b128 v[48:51], v19 offset:0
  ds_read_b128 v[52:55], v19 offset:16
  ds_read_b128 v[56:59], v19 offset:32
  ds_read_b128 v[60:63], v19 offset:48
  ds_read_b128 v[64:67], v19 offset:64
  ds_read_b128 v[68:71], v19 offset:80
  ds_read_b128 v[72:75], v19 offset:96
  ds_read_b128 v[76:79], v19 offset:112
  s_waitcnt vmcnt(31) lgkmcnt(7)
  v_dot2_f32_bf16 v12, v192, v48, v12
  v_dot2_f32_bf16 v13, v192, v49, v13
  v_dot2_f32_bf16 v14, v193, v48, v14
  v_dot2_f32_bf16 v15, v193, v49, v15
  v_dot2_f32_bf16 v16, v194, v48, v16
  v_dot2_f32_bf16 v17, v194, v49, v17
  buffer_load_dwordx3 v[192:194], v3, s[8:11], s63 offen offset:0 nt
  s_waitcnt vmcnt(31)
  v_dot2_f32_bf16 v12, v196, v50, v12
  v_dot2_f32_bf16 v13, v196, v51, v13
  v_dot2_f32_bf16 v14, v197, v50, v14
  v_dot2_f32_bf16 v15, v197, v51, v15
  v_dot2_f32_bf16 v16, v198, v50, v16
  v_dot2_f32_bf16 v17, v198, v51, v17
  buffer_load_dwordx3 v[196:198], v3, s[8:11], s63 offen offset:768 nt
  s_waitcnt vmcnt(31) lgkmcnt(6)
  v_dot2_f32_bf16 v12, v200, v52, v12
  v_dot2_f32_bf16 v13, v200, v53, v13
  v_dot2_f32_bf16 v14, v201, v52, v14
  v_dot2_f32_bf16 v15, v201, v53, v15
  v_dot2_f32_bf16 v16, v202, v52, v16
  v_dot2_f32_bf16 v17, v202, v53, v17
  buffer_load_dwordx3 v[200:202], v3, s[8:11], s63 offen offset:1536 nt
  s_waitcnt vmcnt(31)
  v_dot2_f32_bf16 v12, v204, v54, v12
  v_dot2_f32_bf16 v13, v204, v55, v13
  v_dot2_f32_bf16 v14, v205, v54, v14
  v_dot2_f32_bf16 v15, v205, v55, v15
  v_dot2_f32_bf16 v16, v206, v54, v16
  v_dot2_f32_bf16 v17, v206, v55, v17
  buffer_load_dwordx3 v[204:206], v3, s[8:11], s63 offen offset:2304 nt
  s_waitcnt vmcnt(31) lgkmcnt(5)
  v_dot2_f32_bf16 v12, v208, v56, v12
  v_dot2_f32_bf16 v13, v208, v57, v13
  v_dot2_f32_bf16 v14, v209, v56, v14
  v_dot2_f32_bf16 v15, v209, v57, v15
  v_dot2_f32_bf16 v16, v210, v56, v16
  v_dot2_f32_bf16 v17, v210, v57, v17
  buffer_load_dwordx3 v[208:210], v3, s[8:11], s63 offen offset:3072 nt
  s_waitcnt vmcnt(31)
  v_dot2_f32_bf16 v12, v212, v58, v12
  v_dot2_f32_bf16 v13, v212, v59, v13
  v_dot2_f32_bf16 v14, v213, v58, v14
  v_dot2_f32_bf16 v15, v213, v59, v15
  v_dot2_f32_bf16 v16, v214, v58, v16
  v_dot2_f32_bf16 v17, v214, v59, v17
  buffer_load_dwordx3 v[212:214], v3, s[8:11], s63 offen offset:3840 nt
  s_waitcnt vmcnt(31) lgkmcnt(4)
  v_dot2_f32_bf16 v12, v216, v60, v12
  v_dot2_f32_bf16 v13, v216, v61, v13
  v_dot2_f32_bf16 v14, v217, v60, v14
  v_dot2_f32_bf16 v15, v217, v61, v15
  v_dot2_f32_bf16 v16, v218, v60, v16
  v_dot2_f32_bf16 v17, v218, v61, v17
  buffer_load_dwordx3 v[216:218], v4, s[8:11], s63 offen offset:0 nt
  s_waitcnt vmcnt(31)
  v_dot2_f32_bf16 v12, v220, v62, v12
  v_dot2_f32_bf16 v13, v220, v63, v13
  v_dot2_f32_bf16 v14, v221, v62, v14
  v_dot2_f32_bf16 v15, v221, v63, v15
  v_dot2_f32_bf16 v16, v222, v62, v16
  v_dot2_f32_bf16 v17, v222, v63, v17
  buffer_load_dwordx3 v[220:222], v4, s[8:11], s63 offen offset:768 nt
  s_waitcnt vmcnt(31) lgkmcnt(3)
  v_dot2_f32_bf16 v12, v224, v64, v12
  v_dot2_f32_bf16 v13, v224, v65, v13
  v_dot2_f32_bf16 v14, v225, v64, v14
  v_dot2_f32_bf16 v15, v225, v65, v15
  v_dot2_f32_bf16 v16, v226, v64, v16
  v_dot2_f32_bf16 v17, v226, v65, v17
  buffer_load_dwordx3 v[224:226], v4, s[8:11], s63 offen offset:1536 nt
  s_waitcnt vmcnt(31)
  v_dot2_f32_bf16 v12, v228, v66, v12
  v_dot2_f32_bf16 v13, v228, v67, v13
  v_dot2_f32_bf16 v14, v229, v66, v14
  v_dot2_f32_bf16 v15, v229, v67, v15
  v_dot2_f32_bf16 v16, v230, v66, v16
  v_dot2_f32_bf16 v17, v230, v67, v17
  buffer_load_dwordx3 v[228:230], v4, s[8:11], s63 offen offset:2304 nt
  s_waitcnt vmcnt(31) lgkmcnt(2)
  v_dot2_f32_bf16 v12, v232, v68, v12
  v_dot2_f32_bf16 v13, v232, v69, v13
  v_dot2_f32_bf16 v14, v233, v68, v14
  v_dot2_f32_bf16 v15, v233, v69, v15
  v_dot2_f32_bf16 v16, v234, v68, v16
  v_dot2_f32_bf16 v17, v234, v69, v17
  buffer_load_dwordx3 v[232:234], v4, s[8:11], s63 offen offset:3072 nt
  s_waitcnt vmcnt(31)
  v_dot2_f32_bf16 v12, v236, v70, v12
  v_dot2_f32_bf16 v13, v236, v71, v13
  v_dot2_f32_bf16 v14, v237, v70, v14
  v_dot2_f32_bf16 v15, v237, v71, v15
  v_dot2_f32_bf16 v16, v238, v70, v16
  v_dot2_f32_bf16 v17, v238, v71, v17
  buffer_load_dwordx3 v[236:238], v4, s[8:11], s63 offen offset:3840 nt
  s_waitcnt vmcnt(31) lgkmcnt(1)
  v_dot2_f32_bf16 v12, v240, v72, v12
  v_dot2_f32_bf16 v13, v240, v73, v13
  v_dot2_f32_bf16 v14, v241, v72, v14
  v_dot2_f32_bf16 v15, v241, v73, v15
  v_dot2_f32_bf16 v16, v242, v72, v16
  v_dot2_f32_bf16 v17, v242, v73, v17
  buffer_load_dwordx3 v[240:242], v5, s[8:11], s63 offen offset:0 nt
  s_waitcnt vmcnt(31)
  v_dot2_f32_bf16 v12, v244, v74, v12
  v_dot2_f32_bf16 v13, v244, v75, v13
  v_dot2_f32_bf16 v14, v245, v74, v14
  v_dot2_f32_bf16 v15, v245, v75, v15
  v_dot2_f32_bf16 v16, v246, v74, v16
  v_dot2_f32_bf16 v17, v246, v75, v17
  buffer_load_dwordx3 v[244:246], v5, s[8:11], s63 offen offset:768 nt
  s_waitcnt vmcnt(31) lgkmcnt(0)
  v_dot2_f32_bf16 v12, v248, v76, v12
  v_dot2_f32_bf16 v13, v248, v77, v13
  v_dot2_f32_bf16 v14, v249, v76, v14
  v_dot2_f32_bf16 v15, v249, v77, v15
  v_dot2_f32_bf16 v16, v250, v76, v16
  v_dot2_f32_bf16 v17, v250, v77, v17
  buffer_load_dwordx3 v[248:250], v5, s[8:11], s63 offen offset:1536 nt
  s_waitcnt vmcnt(31)
  v_dot2_f32_bf16 v12, v252, v78, v12
  v_dot2_f32_bf16 v13, v252, v79, v13
  v_dot2_f32_bf16 v14, v253, v78, v14
  v_dot2_f32_bf16 v15, v253, v79, v15
  v_dot2_f32_bf16 v16, v254, v78, v16
  v_dot2_f32_bf16 v17, v254, v79, v17
  buffer_load_dwordx3 v[252:254], v5, s[8:11], s63 offen offset:2304 nt
  s_sub_u32 s65, s65, 1
  s_cmp_lg_u32 s65, 0
  s_cbranch_scc1 L_loop
  s_add_u32 s63, s63, 393216
  s_mov_b32 s94, 0
  s_branch L_dent
L_dtop:
  s_waitcnt vmcnt(32)
  v_readfirstlane_b32 s94, v25
  s_add_u32 s94, s94, 864
  s_min_u32 s94, s94, 1024
  s_mul_i32 s63, s94, 12288
L_dent:
  s_mov_b64 exec, 1
  global_atomic_add v25, v26, v27, s[92:93] sc0
  s_mov_b64 exec, -1
  s_waitcnt vmcnt(32)
  v_dot2_f32_bf16 v32, v128, v6, 0
  v_dot2_f32_bf16 v32, v129, v7, v32
  v_dot2_f32_bf16 v32, v130, v8, v32
  buffer_load_dwordx3 v[128:130], v3, s[4:7], s63 offen offset:0 nt
  s_waitcnt vmcnt(32)
  v_dot2_f32_bf16 v33, v132, v6, 0
  v_dot2_f32_bf16 v33, v133, v7, v33
  v_dot2_f32_bf16 v33, v134, v8, v33
  buffer_load_dwordx3 v[132:134], v3, s[4:7], s63 offen offset:768 nt
  s_waitcnt vmcnt(32)
  v_dot2_f32_bf16 v34, v136, v6, 0
  v_dot2_f32_bf16 v34, v137, v7, v34
  v_dot2_f32_bf16 v34, v138, v8, v34
  buffer_load_dwordx3 v[136:138], v3, s[4:7], s63 offen offset:1536 nt
  s_waitcnt vmcnt(32)
  v_dot2_f32_bf16 v35, v140, v6, 0
  v_dot2_f32_bf16 v35, v141, v7, v35
  v_dot2_f32_bf16 v35, v142, v8, v35
  buffer_load_dwordx3 v[140:142], v3, s[4:7], s63 offen offset:2304 nt
  v_permlane16_swap_b32 v32, v33
  v_add_f32 v32, v32, v33
  s_waitcnt vmcnt(32)
  v_dot2_f32_bf16 v36, v144, v6, 0
  v_dot2_f32_bf16 v36, v145, v7, v36
  v_dot2_f32_bf16 v36, v146, v8, v36
  buffer_load_dwordx3 v[144:146], v3, s[4:7], s63 offen offset:3072 nt
  s_waitcnt vmcnt(32)
  v_dot2_f32_bf16 v37, v148, v6, 0
  v_dot2_f32_bf16 v37, v149, v7, v37
  v_dot2_f32_bf16 v37, v150, v8, v37
  buffer_load_dwordx3 v[148:150], v3, s[4:7], s63 offen offset:3840 nt
  v_permlane16_swap_b32 v34, v35
  v_add_f32 v34, v34, v35
  s_waitcnt vmcnt(32)
  v_dot2_f32_bf16 v38, v152, v6, 0
  v_dot2_f32_bf16 v38, v153, v7, v38
  v_dot2_f32_bf16 v38, v154, v8, v38
  buffer_load_dwordx3 v[152:154], v4, s[4:7], s63 offen offset:0 nt
  s_waitcnt vmcnt(32)
  v_dot2_f32_bf16 v39, v156, v6, 0
  v_dot2_f32_bf16 v39, v157, v7, v39
  v_dot2_f32_bf16 v39, v158, v8, v39
  buffer_load_dwordx3 v[156:158], v4, s[4:7], s63 offen offset:768 nt
  v_permlane16_swap_b32 v36, v37
  v_add_f32 v36, v36, v37
  s_waitcnt vmcnt(32)
  v_dot2_f32_bf16 v40, v160, v6, 0
  v_dot2_f32_bf16 v40, v161, v7, v40
  v_dot2_f32_bf16 v40, v162, v8, v40
  buffer_load_dwordx3 v[160:162], v4, s[4:7], s63 offen offset:1536 nt
  s_waitcnt vmcnt(32)
  v_dot2_f32_bf16 v41, v164, v6, 0
  v_dot2_f32_bf16 v41, v165, v7, v41
  v_dot2_f32_bf16 v41, v166, v8, v41
  buffer_load_dwordx3 v[164:166], v4, s[4:7], s63 offen offset:2304 nt
  v_permlane16_swap_b32 v38, v39
  v_add_f32 v38, v38, v39
  s_waitcnt vmcnt(32)
  v_dot2_f32_bf16 v42, v168, v6, 0
  v_dot2_f32_bf16 v42, v169, v7, v42
  v_dot2_f32_bf16 v42, v170, v8, v42
  buffer_load_dwordx3 v[168:170], v4, s[4:7], s63 offen offset:3072 nt
  s_waitcnt vmcnt(32)
  v_dot2_f32_bf16 v43, v172, v6, 0
  v_dot2_f32_bf16 v43, v173, v7, v43
  v_dot2_f32_bf16 v43, v174, v8, v43
  buffer_load_dwordx3 v[172:174], v4, s[4:7], s63 offen offset:3840 nt
  v_permlane16_swap_b32 v40, v41
  v_add_f32 v40, v40, v41
  s_waitcnt vmcnt(32)
  v_dot2_f32_bf16 v44, v176, v6, 0
  v_dot2_f32_bf16 v44, v177, v7, v44
  v_dot2_f32_bf16 v44, v178, v8, v44
  buffer_load_dwordx3 v[176:178], v5, s[4:7], s63 offen offset:0 nt
  s_waitcnt vmcnt(32)
  v_dot2_f32_bf16 v45, v180, v6, 0
  v_dot2_f32_bf16 v45, v181, v7, v45
  v_dot2_f32_bf16 v45, v182, v8, v45
  buffer_load_dwordx3 v[180:182], v5, s[4:7], s63 offen offset:768 nt
  v_permlane16_swap_b32 v42, v43
  v_add_f32 v42, v42, v43
  s_waitcnt vmcnt(32)
  v_dot2_f32_bf16 v46, v184, v6, 0
  v_dot2_f32_bf16 v46, v185, v7, v46
  v_dot2_f32_bf16 v46, v186, v8, v46
  buffer_load_dwordx3 v[184:186], v5, s[4:7], s63 offen offset:1536 nt
  s_waitcnt vmcnt(32)
  v_dot2_f32_bf16 v47, v188, v6, 0
  v_dot2_f32_bf16 v47, v189, v7, v47
  v_dot2_f32_bf16 v47, v190, v8, v47
  buffer_load_dwordx3 v[188:190], v5, s[4:7], s63 offen offset:2304 nt
  v_permlane16_swap_b32 v44, v45
  v_add_f32 v44, v44, v45
  s_nop 0
  v_permlane16_swap_b32 v46, v47
  v_add_f32 v46, v46, v47
  v_add_f32_dpp v32, v32, v32 row_ror:8 row_mask:0xf bank_mask:0x3
  v_add_f32_dpp v36, v36, v36 row_ror:8 row_mask:0xf bank_mask:0x3
  v_add_f32_dpp v40, v40, v40 row_ror:8 row_mask:0xf bank_mask:0x3
  v_add_f32_dpp v44, v44, v44 row_ror:8 row_mask:0xf bank_mask:0x3
  v_add_f32_dpp v32, v34, v34 row_ror:8 row_mask:0xf bank_mask:0xc
  v_add_f32_dpp v36, v38, v38 row_ror:8 row_mask:0xf bank_mask:0xc
  v_add_f32_dpp v40, v42, v42 row_ror:8 row_mask:0xf bank_mask:0xc
  v_add_f32_dpp v44, v46, v46 row_ror:8 row_mask:0xf bank_mask:0xc
  s_nop 0
  v_add_f32_dpp v32, v32, v32 row_half_mirror row_mask:0xf bank_mask:0x5
  v_add_f32_dpp v40, v40, v40 row_half_mirror row_mask:0xf bank_mask:0x5
  s_nop 0
  v_add_f32_dpp v32, v36, v36 row_half_mirror row_mask:0xf bank_mask:0xa
  v_add_f32_dpp v40, v44, v44 row_half_mirror row_mask:0xf bank_mask:0xa
  s_nop 1
  v_add_f32_dpp v33, v32, v32 quad_perm:[2,3,0,1] row_mask:0xf bank_mask:0xf
  v_add_f32_dpp v34, v40, v40 quad_perm:[2,3,0,1] row_mask:0xf bank_mask:0xf
  v_cndmask_b32 v32, v33, v34, s[66:67]
  s_nop 1
  v_add_f32_dpp v21, v32, v32 quad_perm:[1,0,3,2] row_mask:0xf bank_mask:0xf
  v_cvt_pk_bf16_f32 v21, v21, v21
  v_and_b32 v21, 0xffff0000, v21
  v_mul_f32 v21, s68, v21
  v_cvt_pk_bf16_f32 v21, v21, v21
  v_and_b32 v21, 0xffff0000, v21
  s_nop 1
  v_max_f32_dpp v22, v21, v21 row_ror:8 row_mask:0xf bank_mask:0xf
  s_nop 1
  v_max_f32_dpp v22, v22, v22 row_ror:4 row_mask:0xf bank_mask:0xf
  s_nop 1
  v_max_f32_dpp v22, v22, v22 row_ror:2 row_mask:0xf bank_mask:0xf
  v_mov_b32 v23, v22
  s_nop 1
  v_permlane16_swap_b32 v22, v23
  v_max_f32 v22, v22, v23
  v_mov_b32 v23, v22
  s_nop 1
  v_permlane32_swap_b32 v22, v23
  v_max_f32 v22, v22, v23
  v_cmp_gt_f32 vcc, v22, v9
  s_cbranch_vccz L_norsd
  v_sub_f32 v23, v9, v22
  v_mul_f32 v23, s69, v23
  v_exp_f32 v23, v23
  v_mov_b32 v9, v22
  v_mul_f32 v12, v12, v23
  v_mul_f32 v13, v13, v23
  v_mul_f32 v14, v14, v23
  v_mul_f32 v15, v15, v23
  v_mul_f32 v16, v16, v23
  v_mul_f32 v17, v17, v23
  v_mul_f32 v10, v10, v23
L_norsd:
  v_sub_f32 v21, v21, v9
  v_mul_f32 v21, s69, v21
  v_exp_f32 v21, v21
  s_nop 0
  v_cvt_pk_bf16_f32 v22, v21, v21
  v_add_f32 v10, v10, v21
  v_and_b32 v22, v22, v20
  ds_write_b32 v18, v22
  ds_read_b128 v[48:51], v19 offset:0
  ds_read_b128 v[52:55], v19 offset:16
  ds_read_b128 v[56:59], v19 offset:32
  ds_read_b128 v[60:63], v19 offset:48
  ds_read_b128 v[64:67], v19 offset:64
  ds_read_b128 v[68:71], v19 offset:80
  ds_read_b128 v[72:75], v19 offset:96
  ds_read_b128 v[76:79], v19 offset:112
  s_waitcnt vmcnt(32) lgkmcnt(7)
  v_dot2_f32_bf16 v12, v192, v48, v12
  v_dot2_f32_bf16 v13, v192, v49, v13
  v_dot2_f32_bf16 v14, v193, v48, v14
  v_dot2_f32_bf16 v15, v193, v49, v15
  v_dot2_f32_bf16 v16, v194, v48, v16
  v_dot2_f32_bf16 v17, v194, v49, v17
  buffer_load_dwordx3 v[192:194], v3, s[8:11], s63 offen offset:0 nt
  s_waitcnt vmcnt(32)
  v_dot2_f32_bf16 v12, v196, v50, v12
  v_dot2_f32_bf16 v13, v196, v51, v13
  v_dot2_f32_bf16 v14, v197, v50, v14
  v_dot2_f32_bf16 v15, v197, v51, v15
  v_dot2_f32_bf16 v16, v198, v50, v16
  v_dot2_f32_bf16 v17, v198, v51, v17
  buffer_load_dwordx3 v[196:198], v3, s[8:11], s63 offen offset:768 nt
  s_waitcnt vmcnt(32) lgkmcnt(6)
  v_dot2_f32_bf16 v12, v200, v52, v12
  v_dot2_f32_bf16 v13, v200, v53, v13
  v_dot2_f32_bf16 v14, v201, v52, v14
  v_dot2_f32_bf16 v15, v201, v53, v15
  v_dot2_f32_bf16 v16, v202, v52, v16
  v_dot2_f32_bf16 v17, v202, v53, v17
  buffer_load_dwordx3 v[200:202], v3, s[8:11], s63 offen offset:1536 nt
  s_waitcnt vmcnt(32)
  v_dot2_f32_bf16 v12, v204, v54, v12
  v_dot2_f32_bf16 v13, v204, v55, v13
  v_dot2_f32_bf16 v14, v205, v54, v14
  v_dot2_f32_bf16 v15, v205, v55, v15
  v_dot2_f32_bf16 v16, v206, v54, v16
  v_dot2_f32_bf16 v17, v206, v55, v17
  buffer_load_dwordx3 v[204:206], v3, s[8:11], s63 offen offset:2304 nt
  s_waitcnt vmcnt(32) lgkmcnt(5)
  v_dot2_f32_bf16 v12, v208, v56, v12
  v_dot2_f32_bf16 v13, v208, v57, v13
  v_dot2_f32_bf16 v14, v209, v56, v14
  v_dot2_f32_bf16 v15, v209, v57, v15
  v_dot2_f32_bf16 v16, v210, v56, v16
  v_dot2_f32_bf16 v17, v210, v57, v17
  buffer_load_dwordx3 v[208:210], v3, s[8:11], s63 offen offset:3072 nt
  s_waitcnt vmcnt(32)
  v_dot2_f32_bf16 v12, v212, v58, v12
  v_dot2_f32_bf16 v13, v212, v59, v13
  v_dot2_f32_bf16 v14, v213, v58, v14
  v_dot2_f32_bf16 v15, v213, v59, v15
  v_dot2_f32_bf16 v16, v214, v58, v16
  v_dot2_f32_bf16 v17, v214, v59, v17
  buffer_load_dwordx3 v[212:214], v3, s[8:11], s63 offen offset:3840 nt
  s_waitcnt vmcnt(32) lgkmcnt(4)
  v_dot2_f32_bf16 v12, v216, v60, v12
  v_dot2_f32_bf16 v13, v216, v61, v13
  v_dot2_f32_bf16 v14, v217, v60, v14
  v_dot2_f32_bf16 v15, v217, v61, v15
  v_dot2_f32_bf16 v16, v218, v60, v16
  v_dot2_f32_bf16 v17, v218, v61, v17
  buffer_load_dwordx3 v[216:218], v4, s[8:11], s63 offen offset:0 nt
  s_waitcnt vmcnt(32)
  v_dot2_f32_bf16 v12, v220, v62, v12
  v_dot2_f32_bf16 v13, v220, v63, v13
  v_dot2_f32_bf16 v14, v221, v62, v14
  v_dot2_f32_bf16 v15, v221, v63, v15
  v_dot2_f32_bf16 v16, v222, v62, v16
  v_dot2_f32_bf16 v17, v222, v63, v17
  buffer_load_dwordx3 v[220:222], v4, s[8:11], s63 offen offset:768 nt
  s_waitcnt vmcnt(32) lgkmcnt(3)
  v_dot2_f32_bf16 v12, v224, v64, v12
  v_dot2_f32_bf16 v13, v224, v65, v13
  v_dot2_f32_bf16 v14, v225, v64, v14
  v_dot2_f32_bf16 v15, v225, v65, v15
  v_dot2_f32_bf16 v16, v226, v64, v16
  v_dot2_f32_bf16 v17, v226, v65, v17
  buffer_load_dwordx3 v[224:226], v4, s[8:11], s63 offen offset:1536 nt
  s_waitcnt vmcnt(32)
  v_dot2_f32_bf16 v12, v228, v66, v12
  v_dot2_f32_bf16 v13, v228, v67, v13
  v_dot2_f32_bf16 v14, v229, v66, v14
  v_dot2_f32_bf16 v15, v229, v67, v15
  v_dot2_f32_bf16 v16, v230, v66, v16
  v_dot2_f32_bf16 v17, v230, v67, v17
  buffer_load_dwordx3 v[228:230], v4, s[8:11], s63 offen offset:2304 nt
  s_waitcnt vmcnt(32) lgkmcnt(2)
  v_dot2_f32_bf16 v12, v232, v68, v12
  v_dot2_f32_bf16 v13, v232, v69, v13
  v_dot2_f32_bf16 v14, v233, v68, v14
  v_dot2_f32_bf16 v15, v233, v69, v15
  v_dot2_f32_bf16 v16, v234, v68, v16
  v_dot2_f32_bf16 v17, v234, v69, v17
  buffer_load_dwordx3 v[232:234], v4, s[8:11], s63 offen offset:3072 nt
  s_waitcnt vmcnt(32)
  v_dot2_f32_bf16 v12, v236, v70, v12
  v_dot2_f32_bf16 v13, v236, v71, v13
  v_dot2_f32_bf16 v14, v237, v70, v14
  v_dot2_f32_bf16 v15, v237, v71, v15
  v_dot2_f32_bf16 v16, v238, v70, v16
  v_dot2_f32_bf16 v17, v238, v71, v17
  buffer_load_dwordx3 v[236:238], v4, s[8:11], s63 offen offset:3840 nt
  s_waitcnt vmcnt(32) lgkmcnt(1)
  v_dot2_f32_bf16 v12, v240, v72, v12
  v_dot2_f32_bf16 v13, v240, v73, v13
  v_dot2_f32_bf16 v14, v241, v72, v14
  v_dot2_f32_bf16 v15, v241, v73, v15
  v_dot2_f32_bf16 v16, v242, v72, v16
  v_dot2_f32_bf16 v17, v242, v73, v17
  buffer_load_dwordx3 v[240:242], v5, s[8:11], s63 offen offset:0 nt
  s_waitcnt vmcnt(32)
  v_dot2_f32_bf16 v12, v244, v74, v12
  v_dot2_f32_bf16 v13, v244, v75, v13
  v_dot2_f32_bf16 v14, v245, v74, v14
  v_dot2_f32_bf16 v15, v245, v75, v15
  v_dot2_f32_bf16 v16, v246, v74, v16
  v_dot2_f32_bf16 v17, v246, v75, v17
  buffer_load_dwordx3 v[244:246], v5, s[8:11], s63 offen offset:768 nt
  s_waitcnt vmcnt(32) lgkmcnt(0)
  v_dot2_f32_bf16 v12, v248, v76, v12
  v_dot2_f32_bf16 v13, v248, v77, v13
  v_dot2_f32_bf16 v14, v249, v76, v14
  v_dot2_f32_bf16 v15, v249, v77, v15
  v_dot2_f32_bf16 v16, v250, v76, v16
  v_dot2_f32_bf16 v17, v250, v77, v17
  buffer_load_dwordx3 v[248:250], v5, s[8:11], s63 offen offset:1536 nt
  s_waitcnt vmcnt(32)
  v_dot2_f32_bf16 v12, v252, v78, v12
  v_dot2_f32_bf16 v13, v252, v79, v13
  v_dot2_f32_bf16 v14, v253, v78, v14
  v_dot2_f32_bf16 v15, v253, v79, v15
  v_dot2_f32_bf16 v16, v254, v78, v16
  v_dot2_f32_bf16 v17, v254, v79, v17
  buffer_load_dwordx3 v[252:254], v5, s[8:11], s63 offen offset:2304 nt
  s_cmp_lt_u32 s94, 1024
  s_cbranch_scc1 L_dtop
  v_mov_b32 v21, v10
  s_nop 1
  v_permlane32_swap_b32 v10, v21
  v_add_f32 v10, v10, v21
  v_mov_b32 v21, v10
  s_nop 1
  v_permlane16_swap_b32 v10, v21
  v_add_f32 v10, v10, v21
  s_nop 1
  v_add_f32_dpp v10, v10, v10 row_ror:8 row_mask:0xf bank_mask:0xf
  s_nop 1
  v_add_f32_dpp v10, v10, v10 row_ror:4 row_mask:0xf bank_mask:0xf
  s_nop 1
  v_add_f32_dpp v10, v10, v10 row_ror:2 row_mask:0xf bank_mask:0xf
  s_nop 1
  v_add_f32_dpp v10, v10, v10 row_ror:1 row_mask:0xf bank_mask:0xf
  v_mul_f32 v10, 0.5, v10
  v_permlane32_swap_b32 v12, v13
  v_permlane32_swap_b32 v14, v15
  v_permlane32_swap_b32 v16, v17
  v_add_f32 v12, v12, v13
  v_add_f32 v14, v14, v15
  v_add_f32 v16, v16, v17
  v_lshrrev_b32 v22, 5, v2
  v_lshl_add_u32 v21, v22, 2, v11
  s_lshl_b32 s64, s3, 10
  s_add_u32 s64, s64, 12288
  v_add_u32 v21, s64, v21
  ds_write_b32 v21, v12 offset:0
  ds_write_b32 v21, v14 offset:8
  ds_write_b32 v21, v16 offset:16
  v_mov_b32 v22, s64
  v_lshlrev_b32 v21, 4, v2
  s_mov_b64 exec, 1
  ds_write_b32 v22, v9 offset:768
  ds_write_b32 v22, v10 offset:772
  ds_add_rtn_u32 v23, v26, v27 offset:21764
  s_mov_b64 exec, -1
  ds_read_b64 v[48:49], v26 offset:13056
  ds_read_b64 v[50:51], v26 offset:14080
  ds_read_b64 v[52:53], v26 offset:15104
  ds_read_b64 v[54:55], v26 offset:16128
  s_mov_b32 exec_hi, 0x1ffff
  ds_read_b128 v[32:35], v21 offset:12288
  ds_read_b128 v[36:39], v21 offset:13312
  ds_read_b128 v[40:43], v21 offset:14336
  ds_read_b128 v[44:47], v21 offset:15360
  s_lshl_b32 s64, s2, 10
  s_add_u32 s64, s64, 589824
  v_add_u32 v24, s64, v21
  s_mov_b32 s12, s38
  s_mov_b32 s13, s39
  s_mov_b32 s14, 1441792
  s_mov_b32 s15, 0x20000
  v_cmp_eq_u32 vcc, 48, v2
  s_waitcnt lgkmcnt(8)
  v_readfirstlane_b32 s64, v23
  s_cmp_lg_u32 s64, 3
  s_waitcnt lgkmcnt(4)
  v_max3_f32 v56, v48, v50, v52
  v_max_f32 v56, v56, v54
  v_sub_f32 v57, v48, v56
  v_sub_f32 v58, v50, v56
  v_sub_f32 v59, v52, v56
  v_sub_f32 v60, v54, v56
  v_mul_f32 v57, s69, v57
  v_mul_f32 v58, s69, v58
  v_mul_f32 v59, s69, v59
  v_mul_f32 v60, s69, v60
  v_exp_f32 v57, v57
  v_exp_f32 v58, v58
  v_exp_f32 v59, v59
  v_exp_f32 v60, v60
  s_waitcnt lgkmcnt(0)
  v_mul_f32 v64, v32, v57
  v_mul_f32 v65, v33, v57
  v_mul_f32 v66, v34, v57
  v_mul_f32 v67, v35, v57
  v_fmac_f32 v64, v36, v58
  v_fmac_f32 v65, v37, v58
  v_fmac_f32 v66, v38, v58
  v_fmac_f32 v67, v39, v58
  v_fmac_f32 v64, v40, v59
  v_fmac_f32 v65, v41, v59
  v_fmac_f32 v66, v42, v59
  v_fmac_f32 v67, v43, v59
  v_fmac_f32 v64, v44, v60
  v_fmac_f32 v65, v45, v60
  v_fmac_f32 v66, v46, v60
  v_fmac_f32 v67, v47, v60
  v_cndmask_b32 v64, v64, v56, vcc
  s_cbranch_scc1 L_sfin
  buffer_store_dwordx4 v[64:67], v24, s[12:15], 0 offen sc1
  s_mov_b64 exec, 1
  ds_write_b32 v26, v27 offset:21768
  s_mov_b64 exec, -1
L_sfin:
  s_mov_b64 exec, -1
  s_waitcnt lgkmcnt(0)
  s_cmp_eq_u32 s61, 0
  s_cbranch_scc1 L_tail
  s_endpgm
L_helper:
  s_setprio 3
  s_sub_u32 s3, s3, 4
  v_mov_b32 v23, 61440
  s_cmp_eq_u32 s3, 3
  s_cbranch_scc1 L_g3
  v_lshrrev_b32 v3, 3, v2
  v_and_b32 v4, 7, v2
  v_mul_u32_u24 v5, 12288, v3
  v_lshl_add_u32 v5, v4, 4, v5
  v_lshlrev_b32 v6, 4, v2
  v_lshlrev_b32 v7, 2, v2
  s_mul_i32 s62, s60, 384
  s_lshl_b32 s63, s3, 7
  s_add_u32 s62, s62, s63
  s_mul_i32 s63, s61, 983040
  s_sub_u32 s65, 7864320, s62
  s_waitcnt lgkmcnt(0)
  s_mov_b32 s8, s16
  s_mov_b32 s9, s17
  s_mov_b32 s10, 1280
  s_mov_b32 s11, 0x20000
  buffer_load_dwordx4 v[16:19], v6, s[8:11], 0 offen
  buffer_load_dword v20, v7, s[8:11], 0 offen offset:1024
  s_add_u32 s12, s22, s62
  s_addc_u32 s13, s23, 0
  s_mov_b32 s14, s65
  s_mov_b32 s15, 0x20000
  buffer_load_dwordx4 v[64:67], v5, s[12:15], s63 offen nt
  s_add_u32 s63, s63, 98304
  buffer_load_dwordx4 v[68:71], v5, s[12:15], s63 offen nt
  s_add_u32 s63, s63, 98304
  buffer_load_dwordx4 v[72:75], v5, s[12:15], s63 offen nt
  s_add_u32 s63, s63, 98304
  buffer_load_dwordx4 v[76:79], v5, s[12:15], s63 offen nt
  s_add_u32 s63, s63, 98304
  buffer_load_dwordx4 v[80:83], v5, s[12:15], s63 offen nt
  s_add_u32 s63, s63, 98304
  buffer_load_dwordx4 v[84:87], v5, s[12:15], s63 offen nt
  s_add_u32 s63, s63, 98304
  buffer_load_dwordx4 v[88:91], v5, s[12:15], s63 offen nt
  s_add_u32 s63, s63, 98304
  buffer_load_dwordx4 v[92:95], v5, s[12:15], s63 offen nt
  s_add_u32 s63, s63, 98304
  buffer_load_dwordx4 v[96:99], v5, s[12:15], s63 offen nt
  s_add_u32 s63, s63, 98304
  buffer_load_dwordx4 v[100:103], v5, s[12:15], s63 offen nt
  s_mov_b32 s4, s38
  s_mov_b32 s5, s39
  s_mov_b32 s6, 1441792
  s_mov_b32 s7, 0x20000
  buffer_load_dword v60, v23, s[4:7], 0 offen sc1
  s_barrier
  s_waitcnt vmcnt(11)
  v_lshlrev_b32 v21, 16, v16
  v_and_b32 v22, 0xffff0000, v16
  v_lshlrev_b32 v23, 16, v17
  v_and_b32 v24, 0xffff0000, v17
  v_lshlrev_b32 v25, 16, v18
  v_and_b32 v26, 0xffff0000, v18
  v_lshlrev_b32 v27, 16, v19
  v_and_b32 v28, 0xffff0000, v19
  v_lshlrev_b32 v29, 16, v20
  v_and_b32 v30, 0xffff0000, v20
  v_add_f32 v12, v21, v22
  v_mul_f32 v13, v21, v21
  v_fmac_f32 v13, v22, v22
  v_add_f32 v12, v12, v23
  v_fmac_f32 v13, v23, v23
  v_add_f32 v12, v12, v24
  v_fmac_f32 v13, v24, v24
  v_add_f32 v12, v12, v25
  v_fmac_f32 v13, v25, v25
  v_add_f32 v12, v12, v26
  v_fmac_f32 v13, v26, v26
  v_add_f32 v12, v12, v27
  v_fmac_f32 v13, v27, v27
  v_add_f32 v12, v12, v28
  v_fmac_f32 v13, v28, v28
  v_add_f32 v12, v12, v29
  v_fmac_f32 v13, v29, v29
  v_add_f32 v12, v12, v30
  v_fmac_f32 v13, v30, v30
  s_nop 1
  v_permlane32_swap_b32 v12, v13
  v_add_f32 v12, v12, v13
  v_mov_b32 v13, v12
  s_nop 1
  v_permlane16_swap_b32 v12, v13
  v_add_f32 v12, v12, v13
  s_nop 1
  v_add_f32_dpp v12, v12, v12 row_ror:8 row_mask:0xf bank_mask:0xf
  s_nop 1
  v_add_f32_dpp v12, v12, v12 row_ror:4 row_mask:0xf bank_mask:0xf
  s_nop 1
  v_add_f32_dpp v12, v12, v12 row_ror:2 row_mask:0xf bank_mask:0xf
  s_nop 1
  v_add_f32_dpp v12, v12, v12 row_ror:1 row_mask:0xf bank_mask:0xf
  v_mov_b32 v13, v12
  s_nop 1
  v_permlane32_swap_b32 v12, v13
  v_mul_f32 v12, 0x3acccccd, v12
  v_mul_f32 v13, 0x3acccccd, v13
  v_fma_f32 v13, -v12, v12, v13
  v_cvt_pk_bf16_f32 v12, v12, v12
  v_and_b32 v12, 0xffff0000, v12
  v_cvt_pk_bf16_f32 v13, v13, v13
  v_and_b32 v13, 0xffff0000, v13
  v_add_f32 v13, 0x3727c5ac, v13
  v_cvt_pk_bf16_f32 v13, v13, v13
  v_and_b32 v13, 0xffff0000, v13
  v_sqrt_f32 v13, v13
  s_nop 0
  v_cvt_pk_bf16_f32 v13, v13, v13
  v_and_b32 v13, 0xffff0000, v13
  v_rcp_f32 v13, v13
  v_sub_f32 v21, v21, v12
  v_sub_f32 v22, v22, v12
  v_cvt_pk_bf16_f32 v16, v21, v22
  v_sub_f32 v23, v23, v12
  v_sub_f32 v24, v24, v12
  v_cvt_pk_bf16_f32 v17, v23, v24
  v_sub_f32 v25, v25, v12
  v_sub_f32 v26, v26, v12
  v_cvt_pk_bf16_f32 v18, v25, v26
  v_sub_f32 v27, v27, v12
  v_sub_f32 v28, v28, v12
  v_cvt_pk_bf16_f32 v19, v27, v28
  v_sub_f32 v29, v29, v12
  v_sub_f32 v30, v30, v12
  v_cvt_pk_bf16_f32 v20, v29, v30
  v_lshlrev_b32 v21, 16, v16
  v_and_b32 v22, 0xffff0000, v16
  v_lshlrev_b32 v23, 16, v17
  v_and_b32 v24, 0xffff0000, v17
  v_lshlrev_b32 v25, 16, v18
  v_and_b32 v26, 0xffff0000, v18
  v_lshlrev_b32 v27, 16, v19
  v_and_b32 v28, 0xffff0000, v19
  v_lshlrev_b32 v29, 16, v20
  v_and_b32 v30, 0xffff0000, v20
  v_mul_f32 v21, v21, v13
  v_mul_f32 v22, v22, v13
  v_cvt_pk_bf16_f32 v16, v21, v22
  v_mul_f32 v23, v23, v13
  v_mul_f32 v24, v24, v13
  v_cvt_pk_bf16_f32 v17, v23, v24
  v_mul_f32 v25, v25, v13
  v_mul_f32 v26, v26, v13
  v_cvt_pk_bf16_f32 v18, v25, v26
  v_mul_f32 v27, v27, v13
  v_mul_f32 v28, v28, v13
  v_cvt_pk_bf16_f32 v19, v27, v28
  v_mul_f32 v29, v29, v13
  v_mul_f32 v30, v30, v13
  v_cvt_pk_bf16_f32 v20, v29, v30
  v_and_b32 v32, 0xffff, v16
  v_lshlrev_b32 v33, 16, v16
  v_lshrrev_b32 v34, 16, v16
  v_and_b32 v35, 0xffff0000, v16
  v_and_b32 v36, 0xffff, v17
  v_lshlrev_b32 v37, 16, v17
  v_lshrrev_b32 v38, 16, v17
  v_and_b32 v39, 0xffff0000, v17
  v_and_b32 v40, 0xffff, v18
  v_lshlrev_b32 v41, 16, v18
  v_lshrrev_b32 v42, 16, v18
  v_and_b32 v43, 0xffff0000, v18
  v_and_b32 v44, 0xffff, v19
  v_lshlrev_b32 v45, 16, v19
  v_lshrrev_b32 v46, 16, v19
  v_and_b32 v47, 0xffff0000, v19
  v_and_b32 v48, 0xffff, v20
  v_lshlrev_b32 v49, 16, v20
  v_lshrrev_b32 v50, 16, v20
  v_and_b32 v51, 0xffff0000, v20
  v_lshlrev_b32 v12, 6, v2
  ds_write_b128 v12, v[32:35] offset:0
  ds_write_b128 v12, v[36:39] offset:16
  ds_write_b128 v12, v[40:43] offset:32
  ds_write_b128 v12, v[44:47] offset:48
  ds_write_b128 v6, v[48:51] offset:4096
  s_mul_i32 s64, s61, 640
  v_lshlrev_b32 v12, 3, v3
  v_add_u32 v12, s64, v12
  ds_read_b64 v[32:33], v12 offset:0
  ds_read_b64 v[34:35], v12 offset:64
  ds_read_b64 v[36:37], v12 offset:128
  ds_read_b64 v[38:39], v12 offset:192
  ds_read_b64 v[40:41], v12 offset:256
  ds_read_b64 v[42:43], v12 offset:320
  ds_read_b64 v[44:45], v12 offset:384
  ds_read_b64 v[46:47], v12 offset:448
  ds_read_b64 v[48:49], v12 offset:512
  ds_read_b64 v[50:51], v12 offset:576
  v_mov_b32 v52, 0
  v_mov_b32 v53, 0
  v_mov_b32 v54, 0
  v_mov_b32 v55, 0
  v_mov_b32 v56, 0
  v_mov_b32 v57, 0
  v_mov_b32 v58, 0
  v_mov_b32 v59, 0
  s_waitcnt vmcnt(10) lgkmcnt(9)
  v_dot2c_f32_bf16 v52, v64, v32
  v_dot2c_f32_bf16 v53, v64, v33
  v_dot2c_f32_bf16 v54, v65, v32
  v_dot2c_f32_bf16 v55, v65, v33
  v_dot2c_f32_bf16 v56, v66, v32
  v_dot2c_f32_bf16 v57, v66, v33
  v_dot2c_f32_bf16 v58, v67, v32
  v_dot2c_f32_bf16 v59, v67, v33
  s_waitcnt vmcnt(9) lgkmcnt(8)
  v_dot2c_f32_bf16 v52, v68, v34
  v_dot2c_f32_bf16 v53, v68, v35
  v_dot2c_f32_bf16 v54, v69, v34
  v_dot2c_f32_bf16 v55, v69, v35
  v_dot2c_f32_bf16 v56, v70, v34
  v_dot2c_f32_bf16 v57, v70, v35
  v_dot2c_f32_bf16 v58, v71, v34
  v_dot2c_f32_bf16 v59, v71, v35
  s_waitcnt vmcnt(8) lgkmcnt(7)
  v_dot2c_f32_bf16 v52, v72, v36
  v_dot2c_f32_bf16 v53, v72, v37
  v_dot2c_f32_bf16 v54, v73, v36
  v_dot2c_f32_bf16 v55, v73, v37
  v_dot2c_f32_bf16 v56, v74, v36
  v_dot2c_f32_bf16 v57, v74, v37
  v_dot2c_f32_bf16 v58, v75, v36
  v_dot2c_f32_bf16 v59, v75, v37
  s_waitcnt vmcnt(7) lgkmcnt(6)
  v_dot2c_f32_bf16 v52, v76, v38
  v_dot2c_f32_bf16 v53, v76, v39
  v_dot2c_f32_bf16 v54, v77, v38
  v_dot2c_f32_bf16 v55, v77, v39
  v_dot2c_f32_bf16 v56, v78, v38
  v_dot2c_f32_bf16 v57, v78, v39
  v_dot2c_f32_bf16 v58, v79, v38
  v_dot2c_f32_bf16 v59, v79, v39
  s_waitcnt vmcnt(6) lgkmcnt(5)
  v_dot2c_f32_bf16 v52, v80, v40
  v_dot2c_f32_bf16 v53, v80, v41
  v_dot2c_f32_bf16 v54, v81, v40
  v_dot2c_f32_bf16 v55, v81, v41
  v_dot2c_f32_bf16 v56, v82, v40
  v_dot2c_f32_bf16 v57, v82, v41
  v_dot2c_f32_bf16 v58, v83, v40
  v_dot2c_f32_bf16 v59, v83, v41
  s_waitcnt vmcnt(5) lgkmcnt(4)
  v_dot2c_f32_bf16 v52, v84, v42
  v_dot2c_f32_bf16 v53, v84, v43
  v_dot2c_f32_bf16 v54, v85, v42
  v_dot2c_f32_bf16 v55, v85, v43
  v_dot2c_f32_bf16 v56, v86, v42
  v_dot2c_f32_bf16 v57, v86, v43
  v_dot2c_f32_bf16 v58, v87, v42
  v_dot2c_f32_bf16 v59, v87, v43
  s_waitcnt vmcnt(4) lgkmcnt(3)
  v_dot2c_f32_bf16 v52, v88, v44
  v_dot2c_f32_bf16 v53, v88, v45
  v_dot2c_f32_bf16 v54, v89, v44
  v_dot2c_f32_bf16 v55, v89, v45
  v_dot2c_f32_bf16 v56, v90, v44
  v_dot2c_f32_bf16 v57, v90, v45
  v_dot2c_f32_bf16 v58, v91, v44
  v_dot2c_f32_bf16 v59, v91, v45
  s_waitcnt vmcnt(3) lgkmcnt(2)
  v_dot2c_f32_bf16 v52, v92, v46
  v_dot2c_f32_bf16 v53, v92, v47
  v_dot2c_f32_bf16 v54, v93, v46
  v_dot2c_f32_bf16 v55, v93, v47
  v_dot2c_f32_bf16 v56, v94, v46
  v_dot2c_f32_bf16 v57, v94, v47
  v_dot2c_f32_bf16 v58, v95, v46
  v_dot2c_f32_bf16 v59, v95, v47
  s_waitcnt vmcnt(2) lgkmcnt(1)
  v_dot2c_f32_bf16 v52, v96, v48
  v_dot2c_f32_bf16 v53, v96, v49
  v_dot2c_f32_bf16 v54, v97, v48
  v_dot2c_f32_bf16 v55, v97, v49
  v_dot2c_f32_bf16 v56, v98, v48
  v_dot2c_f32_bf16 v57, v98, v49
  v_dot2c_f32_bf16 v58, v99, v48
  v_dot2c_f32_bf16 v59, v99, v49
  s_waitcnt vmcnt(1) lgkmcnt(0)
  v_dot2c_f32_bf16 v52, v100, v50
  v_dot2c_f32_bf16 v53, v100, v51
  v_dot2c_f32_bf16 v54, v101, v50
  v_dot2c_f32_bf16 v55, v101, v51
  v_dot2c_f32_bf16 v56, v102, v50
  v_dot2c_f32_bf16 v57, v102, v51
  v_dot2c_f32_bf16 v58, v103, v50
  v_dot2c_f32_bf16 v59, v103, v51
  v_bfe_u32 v12, v2, 5, 1
  v_bfe_u32 v13, v2, 4, 1
  v_lshl_add_u32 v12, v13, 1, v12
  v_bfe_u32 v13, v2, 3, 1
  v_permlane32_swap_b32 v52, v53
  v_permlane32_swap_b32 v54, v55
  v_permlane32_swap_b32 v56, v57
  v_permlane32_swap_b32 v58, v59
  v_lshl_add_u32 v12, v13, 2, v12
  v_lshl_add_u32 v12, v4, 3, v12
  v_add_f32 v52, v52, v53
  v_add_f32 v54, v54, v55
  v_add_f32 v56, v56, v57
  v_add_f32 v58, v58, v59
  s_lshl_b32 s64, s2, 11
  s_lshl_b32 s63, s3, 9
  v_permlane16_swap_b32 v52, v54
  v_permlane16_swap_b32 v56, v58
  s_add_u32 s64, s64, s63
  s_add_u32 s64, s64, 65536
  v_add_f32 v52, v52, v54
  v_add_f32 v56, v56, v58
  v_lshlrev_b32 v12, 3, v12
  v_add_u32 v12, s64, v12
  v_add_f32_dpp v14, v52, v52 row_ror:8 row_mask:0xf bank_mask:0x3
  s_nop 1
  v_add_f32_dpp v14, v56, v56 row_ror:8 row_mask:0xf bank_mask:0xc
  s_waitcnt vmcnt(0)
  v_add_u32 v15, 1, v60
  buffer_store_dwordx2 v[14:15], v12, s[4:7], 0 offen sc1
  s_branch L_gather
L_g3:
  s_mul_i32 s42, s60, 3
  s_mov_b32 s43, 3
  s_mul_i32 s40, s60, 6
  s_sub_u32 s40, s40, 36
  s_cmp_ge_u32 s60, 12
  s_cselect_b32 s42, s40, s42
  s_cselect_b32 s43, 6, s43
  s_mul_i32 s40, s60, 5
  s_sub_u32 s40, s40, 16
  s_cmp_ge_u32 s60, 20
  s_cselect_b32 s42, s40, s42
  s_cselect_b32 s43, 5, s43
  s_mul_i32 s40, s60, 7
  s_sub_u32 s40, s40, 64
  s_cmp_ge_u32 s60, 24
  s_cselect_b32 s42, s40, s42
  s_cselect_b32 s43, 7, s43
  s_sub_u32 s40, s61, 1
  s_add_u32 s42, s42, s40
  s_mul_i32 s52, s42, 205
  s_lshr_b32 s52, s52, 10
  s_mul_i32 s48, s52, 5
  s_sub_u32 s48, s42, s48
  s_cmp_lt_u32 s40, s43
  s_cselect_b32 s41, 4, 0
  s_cmp_lt_u32 s60, 24
  s_cselect_b32 s42, 1, 0
  s_cmp_eq_u32 s61, 0
  s_cselect_b32 s41, s42, s41
  s_cselect_b32 s48, s60, s48
  s_add_u32 s54, s60, 8
  s_cmp_lt_u32 s60, 12
  s_cselect_b32 s54, s54, 0xffff
  s_sub_u32 s42, s60, 24
  s_cmp_ge_u32 s60, 24
  s_cselect_b32 s54, s42, s54
  s_cmp_eq_u32 s61, 0
  s_cselect_b32 s54, s54, 0xffff
  s_lshl_b32 s42, s52, 5
  s_lshl_b32 s43, s48, 14
  s_add_u32 s42, s42, s43
  s_add_u32 s42, s42, 1114112
  v_lshrrev_b32 v5, 2, v2
  v_lshlrev_b32 v5, 10, v5
  v_and_b32 v13, 3, v2
  v_lshl_add_u32 v5, v13, 3, v5
  v_add_u32 v5, s42, v5
  v_and_b32 v20, 1, v2
  v_mul_u32_u24 v20, 3328, v20
  v_lshrrev_b32 v13, 1, v2
  v_lshl_add_u32 v20, v13, 2, v20
  s_lshl_b32 s42, s48, 7
  s_add_u32 s42, s42, 1015808
  v_add_u32 v20, s42, v20
  s_lshl_b32 s42, s2, 10
  s_add_u32 s42, s42, 589824
  s_lshl_b32 s64, s60, 8
  s_add_u32 s64, s64, 32768
  v_mov_b32 v21, s64
  v_mov_b32 v22, 0
  v_mov_b32 v24, 0
  v_mov_b32 v25, 0
  v_mov_b32 v26, 0
  v_mov_b32 v27, 0
  ds_write_b128 v22, v[24:27] offset:21760
  ds_write_b128 v22, v[24:27] offset:21776
  v_lshlrev_b32 v16, 4, v2
  v_add_u32 v16, s42, v16
  v_mov_b32 v12, -1
  v_mov_b32 v13, -1
  v_mov_b32 v14, -1
  v_mov_b32 v15, -1
  s_waitcnt lgkmcnt(0)
  s_mov_b32 s4, s38
  s_mov_b32 s5, s39
  s_mov_b32 s6, 1441792
  s_mov_b32 s7, 0x20000
  buffer_load_dword v60, v23, s[4:7], 0 offen sc1
  buffer_store_dwordx4 v[12:15], v16, s[4:7], 0 offen sc1
  s_cmp_lg_u32 s61, 0
  s_cbranch_scc1 L_notk
  s_mov_b64 exec, 1
  buffer_store_dword v22, v21, s[4:7], 0 offen sc1
  s_mov_b64 exec, -1
L_notk:
  s_cmp_eq_u32 s41, 4
  s_cbranch_scc0 L_clr_nsb
  buffer_store_dwordx2 v[12:13], v5, s[4:7], 0 offen sc1
  s_branch L_clr_done
L_clr_nsb:
  s_cmp_lg_u32 s61, 0
  s_cbranch_scc1 L_clr_done
  v_lshlrev_b32 v8, 9, v2
  s_lshl_b32 s42, s60, 4
  s_add_u32 s42, s42, 950272
  s_cmp_lt_u32 s60, 16
  s_cselect_b32 s43, 7, 3
  s_mov_b32 exec_hi, 0
  s_mov_b32 exec_lo, s43
  buffer_store_dwordx4 v[12:15], v8, s[4:7], s42 offen sc1
  s_mov_b64 exec, -1
  s_cmp_eq_u32 s41, 1
  s_cbranch_scc0 L_clr_done
  buffer_store_dword v12, v20, s[4:7], 0 offen sc1
L_clr_done:
  s_barrier
  s_lshl_b32 s64, s2, 11
  s_add_u32 s64, s64, 67072
  v_mov_b32 v12, s64
  s_waitcnt vmcnt(0)
  v_add_u32 v15, 1, v60
  v_mov_b32 v14, 0
  s_mov_b64 exec, 1
  buffer_store_dwordx2 v[14:15], v12, s[4:7], 0 offen sc1
  s_mov_b64 exec, -1
L_gather:
  s_lshl_b32 s62, s3, 1
  s_lshl_b32 s63, s60, 3
  s_add_u32 s63, s63, s62
  s_lshl_b32 s63, s63, 11
  s_add_u32 s63, s63, 65536
  s_mul_i32 s64, s62, 768
  s_add_u32 s64, s64, 5120
  v_lshlrev_b32 v32, 4, v2
  v_add_u32 v32, s63, v32
  v_cmp_gt_u32 vcc, 32, v2
  v_add_u32 v33, 1024, v32
  v_add_u32 v34, 1536, v32
  v_cndmask_b32 v33, v34, v33, vcc
  v_add_u32 v34, 2560, v32
  v_lshlrev_b32 v35, 3, v2
  v_add_u32 v35, s64, v35
  v_add_u32 v36, 512, v35
  v_add_u32 v37, 512, v35
  v_cndmask_b32 v36, v37, v36, vcc
  v_add_u32 v37, 1024, v35
  v_lshrrev_b32 v38, 5, v2
  v_lshlrev_b32 v38, 11, v38
  s_add_u32 s64, s63, 1540
  v_add_u32 v38, s64, v38
  v_add_u32 v15, 1, v60
  s_mov_b32 s58, 20000
L_qx:
  buffer_load_dwordx4 v[40:43], v32, s[4:7], 0 offen sc1
  buffer_load_dwordx4 v[44:47], v33, s[4:7], 0 offen sc1
  buffer_load_dwordx4 v[48:51], v34, s[4:7], 0 offen sc1
  buffer_load_dword v39, v38, s[4:7], 0 offen sc1
  s_waitcnt vmcnt(0)
  v_xor_b32 v52, v41, v15
  v_xor_b32 v53, v43, v15
  v_xor_b32 v54, v45, v15
  v_xor_b32 v55, v47, v15
  v_xor_b32 v56, v49, v15
  v_xor_b32 v57, v51, v15
  v_xor_b32 v58, v39, v15
  v_or3_b32 v52, v52, v53, v54
  v_or3_b32 v55, v55, v56, v57
  v_or3_b32 v52, v52, v55, v58
  v_cmp_ne_u32 vcc, 0, v52
  s_cbranch_vccz L_qx_ok
  s_sub_u32 s58, s58, 1
  s_cbranch_scc0 L_qx
L_qx_ok:
  ds_write2_b32 v35, v40, v42 offset0:0 offset1:1
  ds_write2_b32 v36, v44, v46 offset0:0 offset1:1
  ds_write2_b32 v37, v48, v50 offset0:0 offset1:1
  v_readfirstlane_b32 s59, v15
  s_waitcnt lgkmcnt(0)
  s_barrier
  s_setprio 0
  v_mov_b32 v11, 0
  s_mov_b32 s56, 0x05040100
  s_mov_b32 s57, 0x07060302
  s_mov_b32 s51, 0xffff0000
  s_mov_b32 s69, 0x3fb8aa3b
  s_cmp_eq_u32 s3, 3
  s_cbranch_scc1 L_pub
  s_mul_i32 s42, s60, 3
  s_mov_b32 s43, 3
  s_mul_i32 s40, s60, 6
  s_sub_u32 s40, s40, 36
  s_cmp_ge_u32 s60, 12
  s_cselect_b32 s42, s40, s42
  s_cselect_b32 s43, 6, s43
  s_mul_i32 s40, s60, 5
  s_sub_u32 s40, s40, 16
  s_cmp_ge_u32 s60, 20
  s_cselect_b32 s42, s40, s42
  s_cselect_b32 s43, 5, s43
  s_mul_i32 s40, s60, 7
  s_sub_u32 s40, s40, 64
  s_cmp_ge_u32 s60, 24
  s_cselect_b32 s42, s40, s42
  s_cselect_b32 s43, 7, s43
  s_sub_u32 s40, s61, 1
  s_add_u32 s42, s42, s40
  s_mul_i32 s52, s42, 205
  s_lshr_b32 s52, s52, 10
  s_mul_i32 s48, s52, 5
  s_sub_u32 s48, s42, s48
  s_cmp_lt_u32 s40, s43
  s_cselect_b32 s41, 4, 0
  s_cmp_lt_u32 s60, 24
  s_cselect_b32 s42, 1, 0
  s_cmp_eq_u32 s61, 0
  s_cselect_b32 s41, s42, s41
  s_cselect_b32 s48, s60, s48
  s_add_u32 s54, s60, 8
  s_cmp_lt_u32 s60, 12
  s_cselect_b32 s54, s54, 0xffff
  s_sub_u32 s42, s60, 24
  s_cmp_ge_u32 s60, 24
  s_cselect_b32 s54, s42, s54
  s_cmp_eq_u32 s61, 0
  s_cselect_b32 s54, s54, 0xffff
  s_branch L_disp
L_pub:
  s_cmp_lg_u32 s61, 0
  s_cbranch_scc1 L_disp
  s_getreg_b32 s42, hwreg(HW_REG_XCC_ID, 0, 4)
  s_mul_i32 s43, s42, s42
  s_lshl_b32 s43, s43, 15
  s_lshl_b32 s42, s42, 6
  s_add_u32 s42, s42, s43
  s_add_u32 s42, s42, 1
  v_mov_b32 v13, s42
  s_mov_b64 exec, 1
  global_atomic_add v11, v13, s[36:37]
  s_mov_b64 exec, -1
L_disp:
  s_cmp_eq_u32 s41, 4
  s_cbranch_scc1 L_sb
  s_cmp_eq_u32 s54, 0xffff
  s_cbranch_scc1 L_disp2
  s_lshl_b32 s42, s54, 6
  s_mul_i32 s43, s3, 491520
  s_add_u32 s42, s42, s43
  s_sub_u32 s43, 1966080, s42
  s_add_u32 s8, s32, s42
  s_addc_u32 s9, s33, 0
  s_mov_b32 s10, s43
  s_mov_b32 s11, 0x20000
  v_lshrrev_b32 v16, 2, v2
  v_mul_u32_u24 v16, 30720, v16
  v_and_b32 v13, 3, v2
  v_lshl_add_u32 v16, v13, 4, v16
  s_mov_b32 s42, 0
  buffer_load_dwordx4 v[48:51], v16, s[8:11], s42 offen nt
  buffer_load_dwordx4 v[52:55], v16, s[8:11], s42 offen offset:1280 nt
  s_mov_b32 s42, 2560
  buffer_load_dwordx4 v[56:59], v16, s[8:11], s42 offen nt
  buffer_load_dwordx4 v[60:63], v16, s[8:11], s42 offen offset:1280 nt
  s_mov_b32 s42, 5120
  buffer_load_dwordx4 v[64:67], v16, s[8:11], s42 offen nt
  buffer_load_dwordx4 v[68:71], v16, s[8:11], s42 offen offset:1280 nt
  s_mov_b32 s42, 7680
  buffer_load_dwordx4 v[72:75], v16, s[8:11], s42 offen nt
  buffer_load_dwordx4 v[76:79], v16, s[8:11], s42 offen offset:1280 nt
  s_mov_b32 s42, 10240
  buffer_load_dwordx4 v[80:83], v16, s[8:11], s42 offen nt
  buffer_load_dwordx4 v[84:87], v16, s[8:11], s42 offen offset:1280 nt
  s_mov_b32 s42, 12800
  buffer_load_dwordx4 v[88:91], v16, s[8:11], s42 offen nt
  buffer_load_dwordx4 v[92:95], v16, s[8:11], s42 offen offset:1280 nt
  s_mov_b32 s42, 15360
  buffer_load_dwordx4 v[96:99], v16, s[8:11], s42 offen nt
  buffer_load_dwordx4 v[100:103], v16, s[8:11], s42 offen offset:1280 nt
  s_mov_b32 s42, 17920
  buffer_load_dwordx4 v[104:107], v16, s[8:11], s42 offen nt
  buffer_load_dwordx4 v[108:111], v16, s[8:11], s42 offen offset:1280 nt
  s_mov_b32 s42, 20480
  buffer_load_dwordx4 v[112:115], v16, s[8:11], s42 offen nt
  buffer_load_dwordx4 v[116:119], v16, s[8:11], s42 offen offset:1280 nt
  s_mov_b32 s42, 23040
  buffer_load_dwordx4 v[120:123], v16, s[8:11], s42 offen nt
  buffer_load_dwordx4 v[124:127], v16, s[8:11], s42 offen offset:1280 nt
  s_mov_b32 s42, 25600
  buffer_load_dwordx4 v[128:131], v16, s[8:11], s42 offen nt
  buffer_load_dwordx4 v[132:135], v16, s[8:11], s42 offen offset:1280 nt
  s_mov_b32 s42, 28160
  buffer_load_dwordx4 v[136:139], v16, s[8:11], s42 offen nt
  buffer_load_dwordx4 v[140:143], v16, s[8:11], s42 offen offset:1280 nt
  s_mul_i32 s42, s3, 24576
  s_add_u32 s42, s42, 28480
  v_lshl_add_u32 v17, v2, 4, s42
  s_waitcnt vmcnt(22)
  v_perm_b32 v144, v52, v48, s56
  v_perm_b32 v145, v52, v48, s57
  v_perm_b32 v146, v53, v49, s56
  v_perm_b32 v147, v53, v49, s57
  v_perm_b32 v148, v54, v50, s56
  v_perm_b32 v149, v54, v50, s57
  v_perm_b32 v150, v55, v51, s56
  v_perm_b32 v151, v55, v51, s57
  ds_write_b128 v17, v[144:147] offset:0
  ds_write_b128 v17, v[148:151] offset:1024
  s_waitcnt vmcnt(20)
  v_perm_b32 v152, v60, v56, s56
  v_perm_b32 v153, v60, v56, s57
  v_perm_b32 v154, v61, v57, s56
  v_perm_b32 v155, v61, v57, s57
  v_perm_b32 v156, v62, v58, s56
  v_perm_b32 v157, v62, v58, s57
  v_perm_b32 v158, v63, v59, s56
  v_perm_b32 v159, v63, v59, s57
  ds_write_b128 v17, v[152:155] offset:2048
  ds_write_b128 v17, v[156:159] offset:3072
  s_waitcnt vmcnt(18)
  v_perm_b32 v160, v68, v64, s56
  v_perm_b32 v161, v68, v64, s57
  v_perm_b32 v162, v69, v65, s56
  v_perm_b32 v163, v69, v65, s57
  v_perm_b32 v164, v70, v66, s56
  v_perm_b32 v165, v70, v66, s57
  v_perm_b32 v166, v71, v67, s56
  v_perm_b32 v167, v71, v67, s57
  ds_write_b128 v17, v[160:163] offset:4096
  ds_write_b128 v17, v[164:167] offset:5120
  s_waitcnt vmcnt(16)
  v_perm_b32 v168, v76, v72, s56
  v_perm_b32 v169, v76, v72, s57
  v_perm_b32 v170, v77, v73, s56
  v_perm_b32 v171, v77, v73, s57
  v_perm_b32 v172, v78, v74, s56
  v_perm_b32 v173, v78, v74, s57
  v_perm_b32 v174, v79, v75, s56
  v_perm_b32 v175, v79, v75, s57
  ds_write_b128 v17, v[168:171] offset:6144
  ds_write_b128 v17, v[172:175] offset:7168
  s_waitcnt vmcnt(14)
  v_perm_b32 v176, v84, v80, s56
  v_perm_b32 v177, v84, v80, s57
  v_perm_b32 v178, v85, v81, s56
  v_perm_b32 v179, v85, v81, s57
  v_perm_b32 v180, v86, v82, s56
  v_perm_b32 v181, v86, v82, s57
  v_perm_b32 v182, v87, v83, s56
  v_perm_b32 v183, v87, v83, s57
  ds_write_b128 v17, v[176:179] offset:8192
  ds_write_b128 v17, v[180:183] offset:9216
  s_waitcnt vmcnt(12)
  v_perm_b32 v184, v92, v88, s56
  v_perm_b32 v185, v92, v88, s57
  v_perm_b32 v186, v93, v89, s56
  v_perm_b32 v187, v93, v89, s57
  v_perm_b32 v188, v94, v90, s56
  v_perm_b32 v189, v94, v90, s57
  v_perm_b32 v190, v95, v91, s56
  v_perm_b32 v191, v95, v91, s57
  ds_write_b128 v17, v[184:187] offset:10240
  ds_write_b128 v17, v[188:191] offset:11264
  s_waitcnt vmcnt(10)
  v_perm_b32 v192, v100, v96, s56
  v_perm_b32 v193, v100, v96, s57
  v_perm_b32 v194, v101, v97, s56
  v_perm_b32 v195, v101, v97, s57
  v_perm_b32 v196, v102, v98, s56
  v_perm_b32 v197, v102, v98, s57
  v_perm_b32 v198, v103, v99, s56
  v_perm_b32 v199, v103, v99, s57
  ds_write_b128 v17, v[192:195] offset:12288
  ds_write_b128 v17, v[196:199] offset:13312
  s_waitcnt vmcnt(8)
  v_perm_b32 v200, v108, v104, s56
  v_perm_b32 v201, v108, v104, s57
  v_perm_b32 v202, v109, v105, s56
  v_perm_b32 v203, v109, v105, s57
  v_perm_b32 v204, v110, v106, s56
  v_perm_b32 v205, v110, v106, s57
  v_perm_b32 v206, v111, v107, s56
  v_perm_b32 v207, v111, v107, s57
  ds_write_b128 v17, v[200:203] offset:14336
  ds_write_b128 v17, v[204:207] offset:15360
  s_waitcnt vmcnt(6)
  v_perm_b32 v208, v116, v112, s56
  v_perm_b32 v209, v116, v112, s57
  v_perm_b32 v210, v117, v113, s56
  v_perm_b32 v211, v117, v113, s57
  v_perm_b32 v212, v118, v114, s56
  v_perm_b32 v213, v118, v114, s57
  v_perm_b32 v214, v119, v115, s56
  v_perm_b32 v215, v119, v115, s57
  ds_write_b128 v17, v[208:211] offset:16384
  ds_write_b128 v17, v[212:215] offset:17408
  s_waitcnt vmcnt(4)
  v_perm_b32 v216, v124, v120, s56
  v_perm_b32 v217, v124, v120, s57
  v_perm_b32 v218, v125, v121, s56
  v_perm_b32 v219, v125, v121, s57
  v_perm_b32 v220, v126, v122, s56
  v_perm_b32 v221, v126, v122, s57
  v_perm_b32 v222, v127, v123, s56
  v_perm_b32 v223, v127, v123, s57
  ds_write_b128 v17, v[216:219] offset:18432
  ds_write_b128 v17, v[220:223] offset:19456
  s_waitcnt vmcnt(2)
  v_perm_b32 v224, v132, v128, s56
  v_perm_b32 v225, v132, v128, s57
  v_perm_b32 v226, v133, v129, s56
  v_perm_b32 v227, v133, v129, s57
  v_perm_b32 v228, v134, v130, s56
  v_perm_b32 v229, v134, v130, s57
  v_perm_b32 v230, v135, v131, s56
  v_perm_b32 v231, v135, v131, s57
  ds_write_b128 v17, v[224:227] offset:20480
  ds_write_b128 v17, v[228:231] offset:21504
  s_waitcnt vmcnt(0)
  v_perm_b32 v232, v140, v136, s56
  v_perm_b32 v233, v140, v136, s57
  v_perm_b32 v234, v141, v137, s56
  v_perm_b32 v235, v141, v137, s57
  v_perm_b32 v236, v142, v138, s56
  v_perm_b32 v237, v142, v138, s57
  v_perm_b32 v238, v143, v139, s56
  v_perm_b32 v239, v143, v139, s57
  ds_write_b128 v17, v[232:235] offset:22528
  ds_write_b128 v17, v[236:239] offset:23552
L_disp2:
  s_cmp_lg_u32 s61, 0
  s_cbranch_scc1 L_disp3
  s_mov_b32 s49, 0
  s_mov_b32 s46, 0
  s_mov_b32 s47, 0
  s_mov_b32 s53, 0
  s_mov_b32 s55, 0
  v_mov_b32 v3, 0
  v_mov_b32 v23, 0
  v_mov_b32 v22, 0
  s_branch L_red
L_disp3:
  s_cmp_eq_u32 s41, 1
  s_cbranch_scc1 L_gu
  s_cmp_lg_u32 s61, 0
  s_cbranch_scc1 L_fin
  s_mov_b32 s58, 20000
L_hs_dn:
  global_load_dword v13, v11, s[36:37] sc1
  s_waitcnt vmcnt(0)
  v_and_b32 v12, 63, v13
  v_cmp_gt_u32 vcc, 32, v12
  s_cbranch_vccz L_hs_dn_ok
  s_sleep 32
  s_sub_u32 s58, s58, 1
  s_cbranch_scc0 L_hs_dn
L_hs_dn_ok:
  s_getreg_b32 s42, hwreg(HW_REG_XCC_ID, 0, 4)
  s_mul_i32 s43, s42, s42
  s_lshl_b32 s43, s43, 15
  s_lshl_b32 s42, s42, 6
  s_add_u32 s42, s42, s43
  s_add_u32 s42, s42, 1
  s_lshl_b32 s42, s42, 5
  v_readfirstlane_b32 s43, v13
  s_cmp_eq_u32 s42, s43
  s_cselect_b32 s53, 1, 0
  v_mov_b32 v13, s59
  s_add_u32 s42, s53, 1
  v_mov_b32 v14, s42
  v_mov_b32 v12, 1
  s_mov_b64 exec, 1
  ds_write_b32 v11, v13 offset:21760
  ds_write_b32 v11, v14 offset:21776
  ds_add_u32 v11, v12 offset:21788
  s_mov_b64 exec, -1
  s_branch L_fin
L_sb:
  s_lshl_b32 s42, s52, 5
  s_lshl_b32 s43, s48, 14
  s_add_u32 s42, s42, s43
  s_add_u32 s42, s42, 1114112
  v_lshrrev_b32 v5, 2, v2
  v_lshlrev_b32 v5, 10, v5
  v_and_b32 v13, 3, v2
  v_lshl_add_u32 v5, v13, 3, v5
  v_add_u32 v5, s42, v5
  v_and_b32 v12, 15, v2
  v_lshrrev_b32 v13, 4, v2
  v_mul_u32_u24 v13, 12, v13
  s_mul_i32 s42, s3, 48
  v_add3_u32 v13, v13, v12, s42
  v_min_u32 v14, 13, v12
  v_add_u32 v14, 180, v14
  v_cmp_gt_u32 vcc, 12, v12
  s_nop 1
  v_cndmask_b32 v13, v14, v13, vcc
  v_lshlrev_b32 v4, 2, v13
  s_mul_i32 s42, s52, 192
  s_mul_i32 s43, s3, 48
  s_add_u32 s42, s42, s43
  s_mul_i32 s42, s42, 1280
  s_lshl_b32 s43, s48, 8
  s_add_u32 s42, s42, s43
  s_sub_u32 s43, 7864320, s42
  s_add_u32 s8, s24, s42
  s_addc_u32 s9, s25, 0
  s_mov_b32 s10, s43
  s_mov_b32 s11, 0x20000
  v_lshlrev_b32 v16, 2, v2
  s_lshl_b32 s42, s52, 13
  s_add_u32 s62, s42, 589824
  s_add_u32 s63, s62, 4096
  v_lshlrev_b32 v7, 3, v2
  s_lshl_b32 s42, s3, 9
  v_add_u32 v6, s42, v7
  s_mov_b32 s42, 0
  buffer_load_dword v208, v16, s[8:11], s42 offen offset:0 nt
  buffer_load_dword v209, v16, s[8:11], s42 offen offset:1280 nt
  buffer_load_dword v210, v16, s[8:11], s42 offen offset:2560 nt
  s_mov_b32 s42, 3840
  buffer_load_dword v211, v16, s[8:11], s42 offen offset:0 nt
  buffer_load_dword v212, v16, s[8:11], s42 offen offset:1280 nt
  buffer_load_dword v213, v16, s[8:11], s42 offen offset:2560 nt
  s_mov_b32 s42, 7680
  buffer_load_dword v214, v16, s[8:11], s42 offen offset:0 nt
  buffer_load_dword v215, v16, s[8:11], s42 offen offset:1280 nt
  buffer_load_dword v216, v16, s[8:11], s42 offen offset:2560 nt
  s_mov_b32 s42, 11520
  buffer_load_dword v217, v16, s[8:11], s42 offen offset:0 nt
  buffer_load_dword v218, v16, s[8:11], s42 offen offset:1280 nt
  buffer_load_dword v219, v16, s[8:11], s42 offen offset:2560 nt
  s_mov_b32 s42, 15360
  buffer_load_dword v220, v16, s[8:11], s42 offen offset:0 nt
  buffer_load_dword v221, v16, s[8:11], s42 offen offset:1280 nt
  buffer_load_dword v222, v16, s[8:11], s42 offen offset:2560 nt
  s_mov_b32 s42, 19200
  buffer_load_dword v223, v16, s[8:11], s42 offen offset:0 nt
  buffer_load_dword v224, v16, s[8:11], s42 offen offset:1280 nt
  buffer_load_dword v225, v16, s[8:11], s42 offen offset:2560 nt
  s_mov_b32 s42, 23040
  buffer_load_dword v226, v16, s[8:11], s42 offen offset:0 nt
  buffer_load_dword v227, v16, s[8:11], s42 offen offset:1280 nt
  buffer_load_dword v228, v16, s[8:11], s42 offen offset:2560 nt
  s_mov_b32 s42, 26880
  buffer_load_dword v229, v16, s[8:11], s42 offen offset:0 nt
  buffer_load_dword v230, v16, s[8:11], s42 offen offset:1280 nt
  buffer_load_dword v231, v16, s[8:11], s42 offen offset:2560 nt
  s_mov_b32 s42, 30720
  buffer_load_dword v232, v16, s[8:11], s42 offen offset:0 nt
  buffer_load_dword v233, v16, s[8:11], s42 offen offset:1280 nt
  buffer_load_dword v234, v16, s[8:11], s42 offen offset:2560 nt
  s_mov_b32 s42, 34560
  buffer_load_dword v235, v16, s[8:11], s42 offen offset:0 nt
  buffer_load_dword v236, v16, s[8:11], s42 offen offset:1280 nt
  buffer_load_dword v237, v16, s[8:11], s42 offen offset:2560 nt
  s_mov_b32 s42, 38400
  buffer_load_dword v238, v16, s[8:11], s42 offen offset:0 nt
  buffer_load_dword v239, v16, s[8:11], s42 offen offset:1280 nt
  buffer_load_dword v240, v16, s[8:11], s42 offen offset:2560 nt
  s_mov_b32 s42, 42240
  buffer_load_dword v241, v16, s[8:11], s42 offen offset:0 nt
  buffer_load_dword v242, v16, s[8:11], s42 offen offset:1280 nt
  buffer_load_dword v243, v16, s[8:11], s42 offen offset:2560 nt
  s_mov_b32 s42, 46080
  buffer_load_dword v244, v16, s[8:11], s42 offen offset:0 nt
  buffer_load_dword v245, v16, s[8:11], s42 offen offset:1280 nt
  buffer_load_dword v246, v16, s[8:11], s42 offen offset:2560 nt
  s_mov_b32 s42, 49920
  buffer_load_dword v247, v16, s[8:11], s42 offen offset:0 nt
  buffer_load_dword v248, v16, s[8:11], s42 offen offset:1280 nt
  buffer_load_dword v249, v16, s[8:11], s42 offen offset:2560 nt
  s_mov_b32 s42, 53760
  buffer_load_dword v250, v16, s[8:11], s42 offen offset:0 nt
  buffer_load_dword v251, v16, s[8:11], s42 offen offset:1280 nt
  buffer_load_dword v252, v16, s[8:11], s42 offen offset:2560 nt
  s_mov_b32 s42, 57600
  buffer_load_dword v253, v16, s[8:11], s42 offen offset:0 nt
  buffer_load_dword v254, v16, s[8:11], s42 offen offset:1280 nt
  buffer_load_dword v255, v16, s[8:11], s42 offen offset:2560 nt
  s_waitcnt vmcnt(46)
  v_perm_b32 v207, v209, v208, s56
  v_perm_b32 v209, v209, v208, s57
  s_waitcnt vmcnt(44)
  v_perm_b32 v208, v211, v210, s56
  v_perm_b32 v211, v211, v210, s57
  s_waitcnt vmcnt(42)
  v_perm_b32 v210, v213, v212, s56
  v_perm_b32 v213, v213, v212, s57
  s_waitcnt vmcnt(40)
  v_perm_b32 v212, v215, v214, s56
  v_perm_b32 v215, v215, v214, s57
  s_waitcnt vmcnt(38)
  v_perm_b32 v214, v217, v216, s56
  v_perm_b32 v217, v217, v216, s57
  s_waitcnt vmcnt(36)
  v_perm_b32 v216, v219, v218, s56
  v_perm_b32 v219, v219, v218, s57
  s_waitcnt vmcnt(34)
  v_perm_b32 v218, v221, v220, s56
  v_perm_b32 v221, v221, v220, s57
  s_waitcnt vmcnt(32)
  v_perm_b32 v220, v223, v222, s56
  v_perm_b32 v223, v223, v222, s57
  s_waitcnt vmcnt(30)
  v_perm_b32 v222, v225, v224, s56
  v_perm_b32 v225, v225, v224, s57
  s_waitcnt vmcnt(28)
  v_perm_b32 v224, v227, v226, s56
  v_perm_b32 v227, v227, v226, s57
  s_waitcnt vmcnt(26)
  v_perm_b32 v226, v229, v228, s56
  v_perm_b32 v229, v229, v228, s57
  s_waitcnt vmcnt(24)
  v_perm_b32 v228, v231, v230, s56
  v_perm_b32 v231, v231, v230, s57
  s_waitcnt vmcnt(22)
  v_perm_b32 v230, v233, v232, s56
  v_perm_b32 v233, v233, v232, s57
  s_waitcnt vmcnt(20)
  v_perm_b32 v232, v235, v234, s56
  v_perm_b32 v235, v235, v234, s57
  s_waitcnt vmcnt(18)
  v_perm_b32 v234, v237, v236, s56
  v_perm_b32 v237, v237, v236, s57
  s_waitcnt vmcnt(16)
  v_perm_b32 v236, v239, v238, s56
  v_perm_b32 v239, v239, v238, s57
  s_waitcnt vmcnt(14)
  v_perm_b32 v238, v241, v240, s56
  v_perm_b32 v241, v241, v240, s57
  s_waitcnt vmcnt(12)
  v_perm_b32 v240, v243, v242, s56
  v_perm_b32 v243, v243, v242, s57
  s_waitcnt vmcnt(10)
  v_perm_b32 v242, v245, v244, s56
  v_perm_b32 v245, v245, v244, s57
  s_waitcnt vmcnt(8)
  v_perm_b32 v244, v247, v246, s56
  v_perm_b32 v247, v247, v246, s57
  s_waitcnt vmcnt(6)
  v_perm_b32 v246, v249, v248, s56
  v_perm_b32 v249, v249, v248, s57
  s_waitcnt vmcnt(4)
  v_perm_b32 v248, v251, v250, s56
  v_perm_b32 v251, v251, v250, s57
  s_waitcnt vmcnt(2)
  v_perm_b32 v250, v253, v252, s56
  v_perm_b32 v253, v253, v252, s57
  s_waitcnt vmcnt(0)
  v_perm_b32 v252, v255, v254, s56
  v_perm_b32 v255, v255, v254, s57
  s_mov_b32 s49, 0
  s_mov_b32 s58, 0
  s_mov_b32 s47, 0
  s_mov_b32 s53, 0
  v_mov_b32 v3, 0
L_sb_top:
  buffer_load_dword v32, v4, s[4:7], s62 offen offset:0 sc1
  buffer_load_dword v33, v4, s[4:7], s62 offen offset:1024 sc1
  buffer_load_dword v34, v4, s[4:7], s62 offen offset:2048 sc1
  buffer_load_dword v35, v4, s[4:7], s62 offen offset:3072 sc1
  buffer_load_dword v36, v4, s[4:7], s63 offen offset:0 sc1
  buffer_load_dword v37, v4, s[4:7], s63 offen offset:1024 sc1
  buffer_load_dword v38, v4, s[4:7], s63 offen offset:2048 sc1
  buffer_load_dword v39, v4, s[4:7], s63 offen offset:3072 sc1
L_h1:
  s_waitcnt vmcnt(0)
  v_max3_u32 v14, v32, v33, v34
  v_max3_u32 v14, v14, v35, v36
  v_max3_u32 v14, v14, v37, v38
  v_max_u32 v14, v14, v39
  v_cmp_eq_u32 vcc, -1, v14
  s_cbranch_vccnz L_h1_n0
  v_mov_b32 v16, v32
  v_mov_b32 v17, v33
  v_mov_b32 v18, v34
  v_mov_b32 v19, v35
  v_mov_b32 v20, v36
  v_mov_b32 v21, v37
  v_mov_b32 v22, v38
  v_mov_b32 v23, v39
  s_branch L_h1_ok
L_h1_n0:
  buffer_load_dword v32, v4, s[4:7], s62 offen offset:0 sc1
  buffer_load_dword v33, v4, s[4:7], s62 offen offset:1024 sc1
  buffer_load_dword v34, v4, s[4:7], s62 offen offset:2048 sc1
  buffer_load_dword v35, v4, s[4:7], s62 offen offset:3072 sc1
  buffer_load_dword v36, v4, s[4:7], s63 offen offset:0 sc1
  buffer_load_dword v37, v4, s[4:7], s63 offen offset:1024 sc1
  buffer_load_dword v38, v4, s[4:7], s63 offen offset:2048 sc1
  buffer_load_dword v39, v4, s[4:7], s63 offen offset:3072 sc1
  s_sub_u32 s58, s58, 1
  s_cbranch_scc0 L_h1
L_h1_ok:
  v_max3_f32 v12, v16, v17, v18
  v_max3_f32 v13, v19, v20, v21
  v_max3_f32 v12, v12, v22, v23
  v_max_f32 v12, v12, v13
  s_nop 1
  v_mov_b32_dpp v12, v12 row_newbcast:12 row_mask:0xf bank_mask:0xf
  s_nop 1
  v_sub_f32_dpp v24, v16, v12 row_newbcast:12 row_mask:0xf bank_mask:0xf
  v_sub_f32_dpp v25, v17, v12 row_newbcast:12 row_mask:0xf bank_mask:0xf
  v_sub_f32_dpp v26, v18, v12 row_newbcast:12 row_mask:0xf bank_mask:0xf
  v_sub_f32_dpp v27, v19, v12 row_newbcast:12 row_mask:0xf bank_mask:0xf
  v_sub_f32_dpp v28, v20, v12 row_newbcast:12 row_mask:0xf bank_mask:0xf
  v_sub_f32_dpp v29, v21, v12 row_newbcast:12 row_mask:0xf bank_mask:0xf
  v_sub_f32_dpp v30, v22, v12 row_newbcast:12 row_mask:0xf bank_mask:0xf
  v_sub_f32_dpp v31, v23, v12 row_newbcast:12 row_mask:0xf bank_mask:0xf
  v_mul_f32 v24, s69, v24
  v_mul_f32 v25, s69, v25
  v_mul_f32 v26, s69, v26
  v_mul_f32 v27, s69, v27
  v_mul_f32 v28, s69, v28
  v_mul_f32 v29, s69, v29
  v_mul_f32 v30, s69, v30
  v_mul_f32 v31, s69, v31
  v_exp_f32 v24, v24
  v_exp_f32 v25, v25
  v_exp_f32 v26, v26
  v_exp_f32 v27, v27
  v_exp_f32 v28, v28
  v_exp_f32 v29, v29
  v_exp_f32 v30, v30
  v_exp_f32 v31, v31
  s_nop 0
  v_mul_f32 v13, v16, v24
  v_mul_f32 v14, v20, v28
  v_fmac_f32 v13, v17, v25
  v_fmac_f32 v14, v21, v29
  v_fmac_f32 v13, v18, v26
  v_fmac_f32 v14, v22, v30
  v_fmac_f32 v13, v19, v27
  v_fmac_f32 v14, v23, v31
  v_add_f32 v13, v13, v14
  s_nop 1
  v_mov_b32_dpp v14, v13 row_newbcast:13 row_mask:0xf bank_mask:0xf
  v_rcp_f32 v14, v14
  s_nop 0
  v_mul_f32 v13, v13, v14
  s_nop 1
  v_mov_b32_dpp v14, v13 quad_perm:[1,0,3,2] row_mask:0xf bank_mask:0xf
  v_cvt_pk_bf16_f32 v13, v13, v14
  s_nop 0
  v_readlane_b32 s16, v13, 0
  v_readlane_b32 s17, v13, 2
  v_readlane_b32 s18, v13, 4
  v_readlane_b32 s19, v13, 6
  v_readlane_b32 s20, v13, 8
  v_readlane_b32 s21, v13, 10
  v_readlane_b32 s22, v13, 16
  v_readlane_b32 s23, v13, 18
  v_readlane_b32 s24, v13, 20
  v_readlane_b32 s25, v13, 22
  v_readlane_b32 s26, v13, 24
  v_readlane_b32 s27, v13, 26
  v_readlane_b32 s28, v13, 32
  v_readlane_b32 s29, v13, 34
  v_readlane_b32 s30, v13, 36
  v_readlane_b32 s31, v13, 38
  v_readlane_b32 s8, v13, 40
  v_readlane_b32 s9, v13, 42
  v_readlane_b32 s10, v13, 48
  v_readlane_b32 s11, v13, 50
  v_readlane_b32 s12, v13, 52
  v_readlane_b32 s13, v13, 54
  v_readlane_b32 s14, v13, 56
  v_readlane_b32 s15, v13, 58
  v_mov_b32 v14, 0
  v_mov_b32 v15, 0
  v_mov_b32 v16, 0
  v_mov_b32 v17, 0
  v_dot2c_f32_bf16 v14, s16, v207
  v_dot2c_f32_bf16 v15, s16, v209
  v_dot2c_f32_bf16 v16, s17, v208
  v_dot2c_f32_bf16 v17, s17, v211
  v_dot2c_f32_bf16 v14, s18, v210
  v_dot2c_f32_bf16 v15, s18, v213
  v_dot2c_f32_bf16 v16, s19, v212
  v_dot2c_f32_bf16 v17, s19, v215
  v_dot2c_f32_bf16 v14, s20, v214
  v_dot2c_f32_bf16 v15, s20, v217
  v_dot2c_f32_bf16 v16, s21, v216
  v_dot2c_f32_bf16 v17, s21, v219
  v_dot2c_f32_bf16 v14, s22, v218
  v_dot2c_f32_bf16 v15, s22, v221
  v_dot2c_f32_bf16 v16, s23, v220
  v_dot2c_f32_bf16 v17, s23, v223
  v_dot2c_f32_bf16 v14, s24, v222
  v_dot2c_f32_bf16 v15, s24, v225
  v_dot2c_f32_bf16 v16, s25, v224
  v_dot2c_f32_bf16 v17, s25, v227
  v_dot2c_f32_bf16 v14, s26, v226
  v_dot2c_f32_bf16 v15, s26, v229
  v_dot2c_f32_bf16 v16, s27, v228
  v_dot2c_f32_bf16 v17, s27, v231
  v_dot2c_f32_bf16 v14, s28, v230
  v_dot2c_f32_bf16 v15, s28, v233
  v_dot2c_f32_bf16 v16, s29, v232
  v_dot2c_f32_bf16 v17, s29, v235
  v_dot2c_f32_bf16 v14, s30, v234
  v_dot2c_f32_bf16 v15, s30, v237
  v_dot2c_f32_bf16 v16, s31, v236
  v_dot2c_f32_bf16 v17, s31, v239
  v_dot2c_f32_bf16 v14, s8, v238
  v_dot2c_f32_bf16 v15, s8, v241
  v_dot2c_f32_bf16 v16, s9, v240
  v_dot2c_f32_bf16 v17, s9, v243
  v_dot2c_f32_bf16 v14, s10, v242
  v_dot2c_f32_bf16 v15, s10, v245
  v_dot2c_f32_bf16 v16, s11, v244
  v_dot2c_f32_bf16 v17, s11, v247
  v_dot2c_f32_bf16 v14, s12, v246
  v_dot2c_f32_bf16 v15, s12, v249
  v_dot2c_f32_bf16 v16, s13, v248
  v_dot2c_f32_bf16 v17, s13, v251
  v_dot2c_f32_bf16 v14, s14, v250
  v_dot2c_f32_bf16 v15, s14, v253
  v_dot2c_f32_bf16 v16, s15, v252
  v_dot2c_f32_bf16 v17, s15, v255
  s_nop 1
  v_add_f32 v14, v14, v16
  v_add_f32 v15, v15, v17
  ds_write_b64 v6, v[14:15] offset:16384
  s_mov_b64 exec, 1
  ds_add_rtn_u32 v12, v11, v3 offset:21780
  s_mov_b64 exec, -1
  ds_read_b64 v[16:17], v7 offset:16384
  ds_read_b64 v[18:19], v7 offset:16896
  ds_read_b64 v[20:21], v7 offset:17408
  ds_read_b64 v[22:23], v7 offset:17920
  s_waitcnt lgkmcnt(0)
  v_readfirstlane_b32 s42, v12
  s_cmp_lg_u32 s42, s47
  s_cbranch_scc1 L_sb_next
  v_add_f32 v16, v16, v18
  v_add_f32 v17, v17, v19
  v_add_f32 v20, v20, v22
  v_add_f32 v21, v21, v23
  v_add_f32 v16, v16, v20
  v_add_f32 v17, v17, v21
  s_cmp_eq_u32 s49, 0
  s_cbranch_scc1 L_sb_next
  buffer_store_dwordx2 v[16:17], v5, s[4:7], 0 offen sc1
L_sb_next:
  s_cmp_lg_u32 s49, 0
  s_cbranch_scc1 L_fin
L_sb_real:
  s_mov_b32 s49, 1
  s_mov_b32 s47, 3
  v_mov_b32 v3, 1
  s_mov_b32 s58, 20000
L_hs_sb:
  global_load_dword v13, v11, s[36:37] sc1
  s_waitcnt vmcnt(0)
  v_and_b32 v12, 63, v13
  v_cmp_gt_u32 vcc, 32, v12
  s_cbranch_vccz L_hs_sb_ok
  s_sleep 32
  s_sub_u32 s58, s58, 1
  s_cbranch_scc0 L_hs_sb
L_hs_sb_ok:
  s_mov_b32 s58, 20000
L_pw_sb:
  ds_read_b32 v12, v11 offset:21768
  s_waitcnt lgkmcnt(0)
  v_cmp_ne_u32 vcc, 0, v12
  s_cbranch_vccnz L_pw_sb_ok
  s_sleep 2
  s_sub_u32 s58, s58, 1
  s_cbranch_scc0 L_pw_sb
L_pw_sb_ok:
  s_setprio 3
  s_mov_b32 s58, 20000
  s_branch L_sb_top
L_gu:
  v_and_b32 v6, 1, v2
  v_mul_u32_u24 v6, 3328, v6
  v_lshrrev_b32 v13, 1, v2
  v_lshl_add_u32 v6, v13, 2, v6
  s_lshl_b32 s42, s48, 7
  s_add_u32 s42, s42, 1015808
  v_add_u32 v6, s42, v6
  v_lshrrev_b32 v14, 4, v2
  v_and_b32 v15, 15, v2
  v_mul_u32_u24 v4, 80, v14
  s_mul_i32 s42, s3, 320
  s_add_u32 s42, s42, 950272
  v_add_u32 v4, s42, v4
  v_and_b32 v13, 3, v2
  v_lshl_add_u32 v5, v13, 2, v4
  v_add_u32 v5, 64, v5
  v_lshl_add_u32 v4, v15, 2, v4
  v_lshl_add_u32 v13, v15, 2, v14
  s_lshl_b32 s42, s3, 9
  s_add_u32 s42, s42, 19712
  v_lshl_add_u32 v9, v13, 3, s42
  s_lshl_b32 s42, s48, 7
  s_mul_i32 s43, s3, 491520
  s_add_u32 s42, s42, s43
  s_sub_u32 s43, 1966080, s42
  s_add_u32 s8, s28, s42
  s_addc_u32 s9, s29, 0
  s_mov_b32 s10, s43
  s_mov_b32 s11, 0x20000
  s_add_u32 s12, s30, s42
  s_addc_u32 s13, s31, 0
  s_mov_b32 s14, s43
  s_mov_b32 s15, 0x20000
  v_mul_u32_u24 v16, 122880, v14
  v_lshl_add_u32 v16, v15, 3, v16
  s_mov_b32 s42, 0
  buffer_load_dwordx2 v[46:47], v16, s[8:11], s42 offen nt
  buffer_load_dwordx2 v[48:49], v16, s[8:11], s42 offen offset:3072 nt
  buffer_load_dwordx2 v[50:51], v16, s[12:15], s42 offen nt
  buffer_load_dwordx2 v[52:53], v16, s[12:15], s42 offen offset:3072 nt
  s_mov_b32 s42, 6144
  buffer_load_dwordx2 v[54:55], v16, s[8:11], s42 offen nt
  buffer_load_dwordx2 v[56:57], v16, s[8:11], s42 offen offset:3072 nt
  buffer_load_dwordx2 v[58:59], v16, s[12:15], s42 offen nt
  buffer_load_dwordx2 v[60:61], v16, s[12:15], s42 offen offset:3072 nt
  s_mov_b32 s42, 12288
  buffer_load_dwordx2 v[62:63], v16, s[8:11], s42 offen nt
  buffer_load_dwordx2 v[64:65], v16, s[8:11], s42 offen offset:3072 nt
  buffer_load_dwordx2 v[66:67], v16, s[12:15], s42 offen nt
  buffer_load_dwordx2 v[68:69], v16, s[12:15], s42 offen offset:3072 nt
  s_mov_b32 s42, 18432
  buffer_load_dwordx2 v[70:71], v16, s[8:11], s42 offen nt
  buffer_load_dwordx2 v[72:73], v16, s[8:11], s42 offen offset:3072 nt
  buffer_load_dwordx2 v[74:75], v16, s[12:15], s42 offen nt
  buffer_load_dwordx2 v[76:77], v16, s[12:15], s42 offen offset:3072 nt
  s_mov_b32 s42, 24576
  buffer_load_dwordx2 v[78:79], v16, s[8:11], s42 offen nt
  buffer_load_dwordx2 v[80:81], v16, s[8:11], s42 offen offset:3072 nt
  buffer_load_dwordx2 v[82:83], v16, s[12:15], s42 offen nt
  buffer_load_dwordx2 v[84:85], v16, s[12:15], s42 offen offset:3072 nt
  s_mov_b32 s42, 30720
  buffer_load_dwordx2 v[86:87], v16, s[8:11], s42 offen nt
  buffer_load_dwordx2 v[88:89], v16, s[8:11], s42 offen offset:3072 nt
  buffer_load_dwordx2 v[90:91], v16, s[12:15], s42 offen nt
  buffer_load_dwordx2 v[92:93], v16, s[12:15], s42 offen offset:3072 nt
  s_mov_b32 s42, 36864
  buffer_load_dwordx2 v[94:95], v16, s[8:11], s42 offen nt
  buffer_load_dwordx2 v[96:97], v16, s[8:11], s42 offen offset:3072 nt
  buffer_load_dwordx2 v[98:99], v16, s[12:15], s42 offen nt
  buffer_load_dwordx2 v[100:101], v16, s[12:15], s42 offen offset:3072 nt
  s_mov_b32 s42, 43008
  buffer_load_dwordx2 v[102:103], v16, s[8:11], s42 offen nt
  buffer_load_dwordx2 v[104:105], v16, s[8:11], s42 offen offset:3072 nt
  buffer_load_dwordx2 v[106:107], v16, s[12:15], s42 offen nt
  buffer_load_dwordx2 v[108:109], v16, s[12:15], s42 offen offset:3072 nt
  s_mov_b32 s42, 49152
  buffer_load_dwordx2 v[110:111], v16, s[8:11], s42 offen nt
  buffer_load_dwordx2 v[112:113], v16, s[8:11], s42 offen offset:3072 nt
  buffer_load_dwordx2 v[114:115], v16, s[12:15], s42 offen nt
  buffer_load_dwordx2 v[116:117], v16, s[12:15], s42 offen offset:3072 nt
  s_mov_b32 s42, 55296
  buffer_load_dwordx2 v[118:119], v16, s[8:11], s42 offen nt
  buffer_load_dwordx2 v[120:121], v16, s[8:11], s42 offen offset:3072 nt
  buffer_load_dwordx2 v[122:123], v16, s[12:15], s42 offen nt
  buffer_load_dwordx2 v[124:125], v16, s[12:15], s42 offen offset:3072 nt
  s_mov_b32 s42, 61440
  buffer_load_dwordx2 v[126:127], v16, s[8:11], s42 offen nt
  buffer_load_dwordx2 v[128:129], v16, s[8:11], s42 offen offset:3072 nt
  buffer_load_dwordx2 v[130:131], v16, s[12:15], s42 offen nt
  buffer_load_dwordx2 v[132:133], v16, s[12:15], s42 offen offset:3072 nt
  s_mov_b32 s42, 67584
  buffer_load_dwordx2 v[134:135], v16, s[8:11], s42 offen nt
  buffer_load_dwordx2 v[136:137], v16, s[8:11], s42 offen offset:3072 nt
  buffer_load_dwordx2 v[138:139], v16, s[12:15], s42 offen nt
  buffer_load_dwordx2 v[140:141], v16, s[12:15], s42 offen offset:3072 nt
  s_mov_b32 s42, 73728
  buffer_load_dwordx2 v[142:143], v16, s[8:11], s42 offen nt
  buffer_load_dwordx2 v[144:145], v16, s[8:11], s42 offen offset:3072 nt
  buffer_load_dwordx2 v[146:147], v16, s[12:15], s42 offen nt
  buffer_load_dwordx2 v[148:149], v16, s[12:15], s42 offen offset:3072 nt
  s_mov_b32 s42, 79872
  buffer_load_dwordx2 v[150:151], v16, s[8:11], s42 offen nt
  buffer_load_dwordx2 v[152:153], v16, s[8:11], s42 offen offset:3072 nt
  buffer_load_dwordx2 v[154:155], v16, s[12:15], s42 offen nt
  buffer_load_dwordx2 v[156:157], v16, s[12:15], s42 offen offset:3072 nt
  s_mov_b32 s42, 86016
  buffer_load_dwordx2 v[158:159], v16, s[8:11], s42 offen nt
  buffer_load_dwordx2 v[160:161], v16, s[8:11], s42 offen offset:3072 nt
  buffer_load_dwordx2 v[162:163], v16, s[12:15], s42 offen nt
  buffer_load_dwordx2 v[164:165], v16, s[12:15], s42 offen offset:3072 nt
  s_mov_b32 s42, 92160
  buffer_load_dwordx2 v[166:167], v16, s[8:11], s42 offen nt
  buffer_load_dwordx2 v[168:169], v16, s[8:11], s42 offen offset:3072 nt
  buffer_load_dwordx2 v[170:171], v16, s[12:15], s42 offen nt
  buffer_load_dwordx2 v[172:173], v16, s[12:15], s42 offen offset:3072 nt
  s_mov_b32 s42, 98304
  buffer_load_dwordx2 v[174:175], v16, s[8:11], s42 offen nt
  buffer_load_dwordx2 v[176:177], v16, s[8:11], s42 offen offset:3072 nt
  buffer_load_dwordx2 v[178:179], v16, s[12:15], s42 offen nt
  buffer_load_dwordx2 v[180:181], v16, s[12:15], s42 offen offset:3072 nt
  s_mov_b32 s42, 104448
  buffer_load_dwordx2 v[182:183], v16, s[8:11], s42 offen nt
  buffer_load_dwordx2 v[184:185], v16, s[8:11], s42 offen offset:3072 nt
  buffer_load_dwordx2 v[186:187], v16, s[12:15], s42 offen nt
  buffer_load_dwordx2 v[188:189], v16, s[12:15], s42 offen offset:3072 nt
  s_mov_b32 s42, 110592
  buffer_load_dwordx2 v[190:191], v16, s[8:11], s42 offen nt
  buffer_load_dwordx2 v[192:193], v16, s[8:11], s42 offen offset:3072 nt
  buffer_load_dwordx2 v[194:195], v16, s[12:15], s42 offen nt
  buffer_load_dwordx2 v[196:197], v16, s[12:15], s42 offen offset:3072 nt
  s_mov_b32 s42, 116736
  buffer_load_dwordx2 v[198:199], v16, s[8:11], s42 offen nt
  buffer_load_dwordx2 v[200:201], v16, s[8:11], s42 offen offset:3072 nt
  buffer_load_dwordx2 v[202:203], v16, s[12:15], s42 offen nt
  buffer_load_dwordx2 v[204:205], v16, s[12:15], s42 offen offset:3072 nt
  s_waitcnt vmcnt(63)
  v_perm_b32 v45, v48, v46, s56
  v_perm_b32 v48, v48, v46, s57
  v_perm_b32 v46, v49, v47, s56
  v_perm_b32 v49, v49, v47, s57
  s_waitcnt vmcnt(63)
  v_perm_b32 v47, v52, v50, s56
  v_perm_b32 v52, v52, v50, s57
  v_perm_b32 v50, v53, v51, s56
  v_perm_b32 v53, v53, v51, s57
  s_waitcnt vmcnt(63)
  v_perm_b32 v51, v56, v54, s56
  v_perm_b32 v56, v56, v54, s57
  v_perm_b32 v54, v57, v55, s56
  v_perm_b32 v57, v57, v55, s57
  s_waitcnt vmcnt(63)
  v_perm_b32 v55, v60, v58, s56
  v_perm_b32 v60, v60, v58, s57
  v_perm_b32 v58, v61, v59, s56
  v_perm_b32 v61, v61, v59, s57
  s_waitcnt vmcnt(63)
  v_perm_b32 v59, v64, v62, s56
  v_perm_b32 v64, v64, v62, s57
  v_perm_b32 v62, v65, v63, s56
  v_perm_b32 v65, v65, v63, s57
  s_waitcnt vmcnt(63)
  v_perm_b32 v63, v68, v66, s56
  v_perm_b32 v68, v68, v66, s57
  v_perm_b32 v66, v69, v67, s56
  v_perm_b32 v69, v69, v67, s57
  s_waitcnt vmcnt(63)
  v_perm_b32 v67, v72, v70, s56
  v_perm_b32 v72, v72, v70, s57
  v_perm_b32 v70, v73, v71, s56
  v_perm_b32 v73, v73, v71, s57
  s_waitcnt vmcnt(63)
  v_perm_b32 v71, v76, v74, s56
  v_perm_b32 v76, v76, v74, s57
  v_perm_b32 v74, v77, v75, s56
  v_perm_b32 v77, v77, v75, s57
  s_waitcnt vmcnt(62)
  v_perm_b32 v75, v80, v78, s56
  v_perm_b32 v80, v80, v78, s57
  v_perm_b32 v78, v81, v79, s56
  v_perm_b32 v81, v81, v79, s57
  s_waitcnt vmcnt(60)
  v_perm_b32 v79, v84, v82, s56
  v_perm_b32 v84, v84, v82, s57
  v_perm_b32 v82, v85, v83, s56
  v_perm_b32 v85, v85, v83, s57
  s_waitcnt vmcnt(58)
  v_perm_b32 v83, v88, v86, s56
  v_perm_b32 v88, v88, v86, s57
  v_perm_b32 v86, v89, v87, s56
  v_perm_b32 v89, v89, v87, s57
  s_waitcnt vmcnt(56)
  v_perm_b32 v87, v92, v90, s56
  v_perm_b32 v92, v92, v90, s57
  v_perm_b32 v90, v93, v91, s56
  v_perm_b32 v93, v93, v91, s57
  s_waitcnt vmcnt(54)
  v_perm_b32 v91, v96, v94, s56
  v_perm_b32 v96, v96, v94, s57
  v_perm_b32 v94, v97, v95, s56
  v_perm_b32 v97, v97, v95, s57
  s_waitcnt vmcnt(52)
  v_perm_b32 v95, v100, v98, s56
  v_perm_b32 v100, v100, v98, s57
  v_perm_b32 v98, v101, v99, s56
  v_perm_b32 v101, v101, v99, s57
  s_waitcnt vmcnt(50)
  v_perm_b32 v99, v104, v102, s56
  v_perm_b32 v104, v104, v102, s57
  v_perm_b32 v102, v105, v103, s56
  v_perm_b32 v105, v105, v103, s57
  s_waitcnt vmcnt(48)
  v_perm_b32 v103, v108, v106, s56
  v_perm_b32 v108, v108, v106, s57
  v_perm_b32 v106, v109, v107, s56
  v_perm_b32 v109, v109, v107, s57
  s_waitcnt vmcnt(46)
  v_perm_b32 v107, v112, v110, s56
  v_perm_b32 v112, v112, v110, s57
  v_perm_b32 v110, v113, v111, s56
  v_perm_b32 v113, v113, v111, s57
  s_waitcnt vmcnt(44)
  v_perm_b32 v111, v116, v114, s56
  v_perm_b32 v116, v116, v114, s57
  v_perm_b32 v114, v117, v115, s56
  v_perm_b32 v117, v117, v115, s57
  s_waitcnt vmcnt(42)
  v_perm_b32 v115, v120, v118, s56
  v_perm_b32 v120, v120, v118, s57
  v_perm_b32 v118, v121, v119, s56
  v_perm_b32 v121, v121, v119, s57
  s_waitcnt vmcnt(40)
  v_perm_b32 v119, v124, v122, s56
  v_perm_b32 v124, v124, v122, s57
  v_perm_b32 v122, v125, v123, s56
  v_perm_b32 v125, v125, v123, s57
  s_waitcnt vmcnt(38)
  v_perm_b32 v123, v128, v126, s56
  v_perm_b32 v128, v128, v126, s57
  v_perm_b32 v126, v129, v127, s56
  v_perm_b32 v129, v129, v127, s57
  s_waitcnt vmcnt(36)
  v_perm_b32 v127, v132, v130, s56
  v_perm_b32 v132, v132, v130, s57
  v_perm_b32 v130, v133, v131, s56
  v_perm_b32 v133, v133, v131, s57
  s_waitcnt vmcnt(34)
  v_perm_b32 v131, v136, v134, s56
  v_perm_b32 v136, v136, v134, s57
  v_perm_b32 v134, v137, v135, s56
  v_perm_b32 v137, v137, v135, s57
  s_waitcnt vmcnt(32)
  v_perm_b32 v135, v140, v138, s56
  v_perm_b32 v140, v140, v138, s57
  v_perm_b32 v138, v141, v139, s56
  v_perm_b32 v141, v141, v139, s57
  s_waitcnt vmcnt(30)
  v_perm_b32 v139, v144, v142, s56
  v_perm_b32 v144, v144, v142, s57
  v_perm_b32 v142, v145, v143, s56
  v_perm_b32 v145, v145, v143, s57
  s_waitcnt vmcnt(28)
  v_perm_b32 v143, v148, v146, s56
  v_perm_b32 v148, v148, v146, s57
  v_perm_b32 v146, v149, v147, s56
  v_perm_b32 v149, v149, v147, s57
  s_waitcnt vmcnt(26)
  v_perm_b32 v147, v152, v150, s56
  v_perm_b32 v152, v152, v150, s57
  v_perm_b32 v150, v153, v151, s56
  v_perm_b32 v153, v153, v151, s57
  s_waitcnt vmcnt(24)
  v_perm_b32 v151, v156, v154, s56
  v_perm_b32 v156, v156, v154, s57
  v_perm_b32 v154, v157, v155, s56
  v_perm_b32 v157, v157, v155, s57
  s_waitcnt vmcnt(22)
  v_perm_b32 v155, v160, v158, s56
  v_perm_b32 v160, v160, v158, s57
  v_perm_b32 v158, v161, v159, s56
  v_perm_b32 v161, v161, v159, s57
  s_waitcnt vmcnt(20)
  v_perm_b32 v159, v164, v162, s56
  v_perm_b32 v164, v164, v162, s57
  v_perm_b32 v162, v165, v163, s56
  v_perm_b32 v165, v165, v163, s57
  s_waitcnt vmcnt(18)
  v_perm_b32 v163, v168, v166, s56
  v_perm_b32 v168, v168, v166, s57
  v_perm_b32 v166, v169, v167, s56
  v_perm_b32 v169, v169, v167, s57
  s_waitcnt vmcnt(16)
  v_perm_b32 v167, v172, v170, s56
  v_perm_b32 v172, v172, v170, s57
  v_perm_b32 v170, v173, v171, s56
  v_perm_b32 v173, v173, v171, s57
  s_waitcnt vmcnt(14)
  v_perm_b32 v171, v176, v174, s56
  v_perm_b32 v176, v176, v174, s57
  v_perm_b32 v174, v177, v175, s56
  v_perm_b32 v177, v177, v175, s57
  s_waitcnt vmcnt(12)
  v_perm_b32 v175, v180, v178, s56
  v_perm_b32 v180, v180, v178, s57
  v_perm_b32 v178, v181, v179, s56
  v_perm_b32 v181, v181, v179, s57
  s_waitcnt vmcnt(10)
  v_perm_b32 v179, v184, v182, s56
  v_perm_b32 v184, v184, v182, s57
  v_perm_b32 v182, v185, v183, s56
  v_perm_b32 v185, v185, v183, s57
  s_waitcnt vmcnt(8)
  v_perm_b32 v183, v188, v186, s56
  v_perm_b32 v188, v188, v186, s57
  v_perm_b32 v186, v189, v187, s56
  v_perm_b32 v189, v189, v187, s57
  s_waitcnt vmcnt(6)
  v_perm_b32 v187, v192, v190, s56
  v_perm_b32 v192, v192, v190, s57
  v_perm_b32 v190, v193, v191, s56
  v_perm_b32 v193, v193, v191, s57
  s_waitcnt vmcnt(4)
  v_perm_b32 v191, v196, v194, s56
  v_perm_b32 v196, v196, v194, s57
  v_perm_b32 v194, v197, v195, s56
  v_perm_b32 v197, v197, v195, s57
  s_waitcnt vmcnt(2)
  v_perm_b32 v195, v200, v198, s56
  v_perm_b32 v200, v200, v198, s57
  v_perm_b32 v198, v201, v199, s56
  v_perm_b32 v201, v201, v199, s57
  s_waitcnt vmcnt(0)
  v_perm_b32 v199, v204, v202, s56
  v_perm_b32 v204, v204, v202, s57
  v_perm_b32 v202, v205, v203, s56
  v_perm_b32 v205, v205, v203, s57
  s_mov_b32 s46, 0x3f803f80
  v_mov_b32 v17, s46
  v_dot2_f32_bf16 v208, v17, v45, 0
  v_dot2_f32_bf16 v209, v17, v48, 0
  v_dot2_f32_bf16 v210, v17, v46, 0
  v_dot2_f32_bf16 v211, v17, v49, 0
  v_dot2_f32_bf16 v212, v17, v47, 0
  v_dot2_f32_bf16 v213, v17, v52, 0
  v_dot2_f32_bf16 v214, v17, v50, 0
  v_dot2_f32_bf16 v215, v17, v53, 0
  v_dot2c_f32_bf16 v208, v17, v51
  v_dot2c_f32_bf16 v209, v17, v56
  v_dot2c_f32_bf16 v210, v17, v54
  v_dot2c_f32_bf16 v211, v17, v57
  v_dot2c_f32_bf16 v212, v17, v55
  v_dot2c_f32_bf16 v213, v17, v60
  v_dot2c_f32_bf16 v214, v17, v58
  v_dot2c_f32_bf16 v215, v17, v61
  v_dot2c_f32_bf16 v208, v17, v59
  v_dot2c_f32_bf16 v209, v17, v64
  v_dot2c_f32_bf16 v210, v17, v62
  v_dot2c_f32_bf16 v211, v17, v65
  v_dot2c_f32_bf16 v212, v17, v63
  v_dot2c_f32_bf16 v213, v17, v68
  v_dot2c_f32_bf16 v214, v17, v66
  v_dot2c_f32_bf16 v215, v17, v69
  v_dot2c_f32_bf16 v208, v17, v67
  v_dot2c_f32_bf16 v209, v17, v72
  v_dot2c_f32_bf16 v210, v17, v70
  v_dot2c_f32_bf16 v211, v17, v73
  v_dot2c_f32_bf16 v212, v17, v71
  v_dot2c_f32_bf16 v213, v17, v76
  v_dot2c_f32_bf16 v214, v17, v74
  v_dot2c_f32_bf16 v215, v17, v77
  v_dot2c_f32_bf16 v208, v17, v75
  v_dot2c_f32_bf16 v209, v17, v80
  v_dot2c_f32_bf16 v210, v17, v78
  v_dot2c_f32_bf16 v211, v17, v81
  v_dot2c_f32_bf16 v212, v17, v79
  v_dot2c_f32_bf16 v213, v17, v84
  v_dot2c_f32_bf16 v214, v17, v82
  v_dot2c_f32_bf16 v215, v17, v85
  v_dot2c_f32_bf16 v208, v17, v83
  v_dot2c_f32_bf16 v209, v17, v88
  v_dot2c_f32_bf16 v210, v17, v86
  v_dot2c_f32_bf16 v211, v17, v89
  v_dot2c_f32_bf16 v212, v17, v87
  v_dot2c_f32_bf16 v213, v17, v92
  v_dot2c_f32_bf16 v214, v17, v90
  v_dot2c_f32_bf16 v215, v17, v93
  v_dot2c_f32_bf16 v208, v17, v91
  v_dot2c_f32_bf16 v209, v17, v96
  v_dot2c_f32_bf16 v210, v17, v94
  v_dot2c_f32_bf16 v211, v17, v97
  v_dot2c_f32_bf16 v212, v17, v95
  v_dot2c_f32_bf16 v213, v17, v100
  v_dot2c_f32_bf16 v214, v17, v98
  v_dot2c_f32_bf16 v215, v17, v101
  v_dot2c_f32_bf16 v208, v17, v99
  v_dot2c_f32_bf16 v209, v17, v104
  v_dot2c_f32_bf16 v210, v17, v102
  v_dot2c_f32_bf16 v211, v17, v105
  v_dot2c_f32_bf16 v212, v17, v103
  v_dot2c_f32_bf16 v213, v17, v108
  v_dot2c_f32_bf16 v214, v17, v106
  v_dot2c_f32_bf16 v215, v17, v109
  v_dot2c_f32_bf16 v208, v17, v107
  v_dot2c_f32_bf16 v209, v17, v112
  v_dot2c_f32_bf16 v210, v17, v110
  v_dot2c_f32_bf16 v211, v17, v113
  v_dot2c_f32_bf16 v212, v17, v111
  v_dot2c_f32_bf16 v213, v17, v116
  v_dot2c_f32_bf16 v214, v17, v114
  v_dot2c_f32_bf16 v215, v17, v117
  v_dot2c_f32_bf16 v208, v17, v115
  v_dot2c_f32_bf16 v209, v17, v120
  v_dot2c_f32_bf16 v210, v17, v118
  v_dot2c_f32_bf16 v211, v17, v121
  v_dot2c_f32_bf16 v212, v17, v119
  v_dot2c_f32_bf16 v213, v17, v124
  v_dot2c_f32_bf16 v214, v17, v122
  v_dot2c_f32_bf16 v215, v17, v125
  v_dot2c_f32_bf16 v208, v17, v123
  v_dot2c_f32_bf16 v209, v17, v128
  v_dot2c_f32_bf16 v210, v17, v126
  v_dot2c_f32_bf16 v211, v17, v129
  v_dot2c_f32_bf16 v212, v17, v127
  v_dot2c_f32_bf16 v213, v17, v132
  v_dot2c_f32_bf16 v214, v17, v130
  v_dot2c_f32_bf16 v215, v17, v133
  v_dot2c_f32_bf16 v208, v17, v131
  v_dot2c_f32_bf16 v209, v17, v136
  v_dot2c_f32_bf16 v210, v17, v134
  v_dot2c_f32_bf16 v211, v17, v137
  v_dot2c_f32_bf16 v212, v17, v135
  v_dot2c_f32_bf16 v213, v17, v140
  v_dot2c_f32_bf16 v214, v17, v138
  v_dot2c_f32_bf16 v215, v17, v141
  v_dot2c_f32_bf16 v208, v17, v139
  v_dot2c_f32_bf16 v209, v17, v144
  v_dot2c_f32_bf16 v210, v17, v142
  v_dot2c_f32_bf16 v211, v17, v145
  v_dot2c_f32_bf16 v212, v17, v143
  v_dot2c_f32_bf16 v213, v17, v148
  v_dot2c_f32_bf16 v214, v17, v146
  v_dot2c_f32_bf16 v215, v17, v149
  v_dot2c_f32_bf16 v208, v17, v147
  v_dot2c_f32_bf16 v209, v17, v152
  v_dot2c_f32_bf16 v210, v17, v150
  v_dot2c_f32_bf16 v211, v17, v153
  v_dot2c_f32_bf16 v212, v17, v151
  v_dot2c_f32_bf16 v213, v17, v156
  v_dot2c_f32_bf16 v214, v17, v154
  v_dot2c_f32_bf16 v215, v17, v157
  v_dot2c_f32_bf16 v208, v17, v155
  v_dot2c_f32_bf16 v209, v17, v160
  v_dot2c_f32_bf16 v210, v17, v158
  v_dot2c_f32_bf16 v211, v17, v161
  v_dot2c_f32_bf16 v212, v17, v159
  v_dot2c_f32_bf16 v213, v17, v164
  v_dot2c_f32_bf16 v214, v17, v162
  v_dot2c_f32_bf16 v215, v17, v165
  v_dot2c_f32_bf16 v208, v17, v163
  v_dot2c_f32_bf16 v209, v17, v168
  v_dot2c_f32_bf16 v210, v17, v166
  v_dot2c_f32_bf16 v211, v17, v169
  v_dot2c_f32_bf16 v212, v17, v167
  v_dot2c_f32_bf16 v213, v17, v172
  v_dot2c_f32_bf16 v214, v17, v170
  v_dot2c_f32_bf16 v215, v17, v173
  v_dot2c_f32_bf16 v208, v17, v171
  v_dot2c_f32_bf16 v209, v17, v176
  v_dot2c_f32_bf16 v210, v17, v174
  v_dot2c_f32_bf16 v211, v17, v177
  v_dot2c_f32_bf16 v212, v17, v175
  v_dot2c_f32_bf16 v213, v17, v180
  v_dot2c_f32_bf16 v214, v17, v178
  v_dot2c_f32_bf16 v215, v17, v181
  v_dot2c_f32_bf16 v208, v17, v179
  v_dot2c_f32_bf16 v209, v17, v184
  v_dot2c_f32_bf16 v210, v17, v182
  v_dot2c_f32_bf16 v211, v17, v185
  v_dot2c_f32_bf16 v212, v17, v183
  v_dot2c_f32_bf16 v213, v17, v188
  v_dot2c_f32_bf16 v214, v17, v186
  v_dot2c_f32_bf16 v215, v17, v189
  v_dot2c_f32_bf16 v208, v17, v187
  v_dot2c_f32_bf16 v209, v17, v192
  v_dot2c_f32_bf16 v210, v17, v190
  v_dot2c_f32_bf16 v211, v17, v193
  v_dot2c_f32_bf16 v212, v17, v191
  v_dot2c_f32_bf16 v213, v17, v196
  v_dot2c_f32_bf16 v214, v17, v194
  v_dot2c_f32_bf16 v215, v17, v197
  v_dot2c_f32_bf16 v208, v17, v195
  v_dot2c_f32_bf16 v209, v17, v200
  v_dot2c_f32_bf16 v210, v17, v198
  v_dot2c_f32_bf16 v211, v17, v201
  v_dot2c_f32_bf16 v212, v17, v199
  v_dot2c_f32_bf16 v213, v17, v204
  v_dot2c_f32_bf16 v214, v17, v202
  v_dot2c_f32_bf16 v215, v17, v205
  s_nop 0
  s_nop 1
  v_permlane32_swap_b32 v208, v210
  v_permlane32_swap_b32 v209, v211
  v_permlane32_swap_b32 v212, v214
  v_permlane32_swap_b32 v213, v215
  v_add_f32 v208, v208, v210
  v_add_f32 v209, v209, v211
  v_add_f32 v212, v212, v214
  v_add_f32 v213, v213, v215
  s_nop 0
  v_permlane16_swap_b32 v208, v209
  v_permlane16_swap_b32 v212, v213
  s_nop 0
  v_add_f32 v16, v208, v209
  v_add_f32 v17, v212, v213
  ds_write_b64 v9, v[16:17] offset:2080
  v_mov_b32 v26, s46
  v_mov_b32 v27, 0x3e803e80
  v_lshrrev_b32 v24, 5, v2
  s_lshl_b32 s42, s3, 3
  v_lshl_add_u32 v24, v24, 2, s42
  v_lshlrev_b32 v25, 3, v2
  s_mov_b32 s49, 0
  s_mov_b32 s58, 0
  s_mov_b32 s47, 0
  s_mov_b32 s53, 0
  v_mov_b32 v3, 0
L_gu_top:
L_h3:
  buffer_load_dword v32, v4, s[4:7], 0 offen sc1
  buffer_load_dword v33, v5, s[4:7], 0 offen sc1
  s_waitcnt vmcnt(0)
  v_max_u32 v12, v32, v33
  v_cmp_eq_u32 vcc, -1, v12
  s_cbranch_vccz L_h3_ok
  s_sub_u32 s58, s58, 1
  s_cbranch_scc0 L_h3
L_h3_ok:
  v_dot2c_f32_bf16_dpp v208, v32, v45 row_newbcast:0 row_mask:0xf bank_mask:0xf
  v_dot2c_f32_bf16_dpp v209, v32, v48 row_newbcast:0 row_mask:0xf bank_mask:0xf
  v_dot2c_f32_bf16_dpp v210, v32, v46 row_newbcast:0 row_mask:0xf bank_mask:0xf
  v_dot2_f32_bf16 v18, v32, v26, 0
  v_dot2c_f32_bf16_dpp v211, v32, v49 row_newbcast:0 row_mask:0xf bank_mask:0xf
  v_dot2c_f32_bf16_dpp v212, v32, v47 row_newbcast:0 row_mask:0xf bank_mask:0xf
  v_dot2c_f32_bf16_dpp v213, v32, v52 row_newbcast:0 row_mask:0xf bank_mask:0xf
  v_dot2_f32_bf16 v20, v33, v33, 0
  v_dot2c_f32_bf16_dpp v214, v32, v50 row_newbcast:0 row_mask:0xf bank_mask:0xf
  v_dot2c_f32_bf16_dpp v215, v32, v53 row_newbcast:0 row_mask:0xf bank_mask:0xf
  v_dot2c_f32_bf16_dpp v208, v32, v51 row_newbcast:1 row_mask:0xf bank_mask:0xf
  v_dot2_f32_bf16 v19, v32, v32, 0
  v_dot2c_f32_bf16_dpp v209, v32, v56 row_newbcast:1 row_mask:0xf bank_mask:0xf
  v_dot2c_f32_bf16_dpp v210, v32, v54 row_newbcast:1 row_mask:0xf bank_mask:0xf
  v_dot2c_f32_bf16_dpp v211, v32, v57 row_newbcast:1 row_mask:0xf bank_mask:0xf
  v_dot2_f32_bf16 v18, v33, v27, v18
  v_dot2c_f32_bf16_dpp v212, v32, v55 row_newbcast:1 row_mask:0xf bank_mask:0xf
  v_dot2c_f32_bf16_dpp v213, v32, v60 row_newbcast:1 row_mask:0xf bank_mask:0xf
  v_dot2c_f32_bf16_dpp v214, v32, v58 row_newbcast:1 row_mask:0xf bank_mask:0xf
  v_dot2c_f32_bf16_dpp v215, v32, v61 row_newbcast:1 row_mask:0xf bank_mask:0xf
  v_dot2c_f32_bf16_dpp v208, v32, v59 row_newbcast:2 row_mask:0xf bank_mask:0xf
  v_dot2c_f32_bf16_dpp v209, v32, v64 row_newbcast:2 row_mask:0xf bank_mask:0xf
  v_fmac_f32 v19, 0x3e800000, v20
  v_dot2c_f32_bf16_dpp v210, v32, v62 row_newbcast:2 row_mask:0xf bank_mask:0xf
  v_dot2c_f32_bf16_dpp v211, v32, v65 row_newbcast:2 row_mask:0xf bank_mask:0xf
  v_dot2c_f32_bf16_dpp v212, v32, v63 row_newbcast:2 row_mask:0xf bank_mask:0xf
  v_dot2c_f32_bf16_dpp v213, v32, v68 row_newbcast:2 row_mask:0xf bank_mask:0xf
  v_dot2c_f32_bf16_dpp v214, v32, v66 row_newbcast:2 row_mask:0xf bank_mask:0xf
  v_dot2c_f32_bf16_dpp v215, v32, v69 row_newbcast:2 row_mask:0xf bank_mask:0xf
  v_permlane32_swap_b32 v18, v19
  v_dot2c_f32_bf16_dpp v208, v32, v67 row_newbcast:3 row_mask:0xf bank_mask:0xf
  v_dot2c_f32_bf16_dpp v209, v32, v72 row_newbcast:3 row_mask:0xf bank_mask:0xf
  v_dot2c_f32_bf16_dpp v210, v32, v70 row_newbcast:3 row_mask:0xf bank_mask:0xf
  v_add_f32 v18, v18, v19
  v_dot2c_f32_bf16_dpp v211, v32, v73 row_newbcast:3 row_mask:0xf bank_mask:0xf
  v_dot2c_f32_bf16_dpp v212, v32, v71 row_newbcast:3 row_mask:0xf bank_mask:0xf
  v_dot2c_f32_bf16_dpp v213, v32, v76 row_newbcast:3 row_mask:0xf bank_mask:0xf
  v_mov_b32 v19, v18
  v_dot2c_f32_bf16_dpp v214, v32, v74 row_newbcast:3 row_mask:0xf bank_mask:0xf
  v_dot2c_f32_bf16_dpp v215, v32, v77 row_newbcast:3 row_mask:0xf bank_mask:0xf
  v_dot2c_f32_bf16_dpp v208, v32, v75 row_newbcast:4 row_mask:0xf bank_mask:0xf
  v_dot2c_f32_bf16_dpp v209, v32, v80 row_newbcast:4 row_mask:0xf bank_mask:0xf
  v_dot2c_f32_bf16_dpp v210, v32, v78 row_newbcast:4 row_mask:0xf bank_mask:0xf
  v_dot2c_f32_bf16_dpp v211, v32, v81 row_newbcast:4 row_mask:0xf bank_mask:0xf
  v_permlane16_swap_b32 v18, v19
  v_dot2c_f32_bf16_dpp v212, v32, v79 row_newbcast:4 row_mask:0xf bank_mask:0xf
  v_dot2c_f32_bf16_dpp v213, v32, v84 row_newbcast:4 row_mask:0xf bank_mask:0xf
  v_dot2c_f32_bf16_dpp v214, v32, v82 row_newbcast:4 row_mask:0xf bank_mask:0xf
  v_add_f32 v18, v18, v19
  v_dot2c_f32_bf16_dpp v215, v32, v85 row_newbcast:4 row_mask:0xf bank_mask:0xf
  v_dot2c_f32_bf16_dpp v208, v32, v83 row_newbcast:5 row_mask:0xf bank_mask:0xf
  v_dot2c_f32_bf16_dpp v209, v32, v88 row_newbcast:5 row_mask:0xf bank_mask:0xf
  v_dot2c_f32_bf16_dpp v210, v32, v86 row_newbcast:5 row_mask:0xf bank_mask:0xf
  v_dot2c_f32_bf16_dpp v211, v32, v89 row_newbcast:5 row_mask:0xf bank_mask:0xf
  v_dot2c_f32_bf16_dpp v212, v32, v87 row_newbcast:5 row_mask:0xf bank_mask:0xf
  v_add_f32_dpp v18, v18, v18 row_ror:8 row_mask:0xf bank_mask:0xf
  v_dot2c_f32_bf16_dpp v213, v32, v92 row_newbcast:5 row_mask:0xf bank_mask:0xf
  v_dot2c_f32_bf16_dpp v214, v32, v90 row_newbcast:5 row_mask:0xf bank_mask:0xf
  v_dot2c_f32_bf16_dpp v215, v32, v93 row_newbcast:5 row_mask:0xf bank_mask:0xf
  v_dot2c_f32_bf16_dpp v208, v32, v91 row_newbcast:6 row_mask:0xf bank_mask:0xf
  v_dot2c_f32_bf16_dpp v209, v32, v96 row_newbcast:6 row_mask:0xf bank_mask:0xf
  v_dot2c_f32_bf16_dpp v210, v32, v94 row_newbcast:6 row_mask:0xf bank_mask:0xf
  v_add_f32_dpp v18, v18, v18 row_ror:4 row_mask:0xf bank_mask:0xf
  v_dot2c_f32_bf16_dpp v211, v32, v97 row_newbcast:6 row_mask:0xf bank_mask:0xf
  v_dot2c_f32_bf16_dpp v212, v32, v95 row_newbcast:6 row_mask:0xf bank_mask:0xf
  v_dot2c_f32_bf16_dpp v213, v32, v100 row_newbcast:6 row_mask:0xf bank_mask:0xf
  v_dot2c_f32_bf16_dpp v214, v32, v98 row_newbcast:6 row_mask:0xf bank_mask:0xf
  v_dot2c_f32_bf16_dpp v215, v32, v101 row_newbcast:6 row_mask:0xf bank_mask:0xf
  v_dot2c_f32_bf16_dpp v208, v32, v99 row_newbcast:7 row_mask:0xf bank_mask:0xf
  v_add_f32_dpp v18, v18, v18 row_ror:2 row_mask:0xf bank_mask:0xf
  v_dot2c_f32_bf16_dpp v209, v32, v104 row_newbcast:7 row_mask:0xf bank_mask:0xf
  v_dot2c_f32_bf16_dpp v210, v32, v102 row_newbcast:7 row_mask:0xf bank_mask:0xf
  v_dot2c_f32_bf16_dpp v211, v32, v105 row_newbcast:7 row_mask:0xf bank_mask:0xf
  v_dot2c_f32_bf16_dpp v212, v32, v103 row_newbcast:7 row_mask:0xf bank_mask:0xf
  v_dot2c_f32_bf16_dpp v213, v32, v108 row_newbcast:7 row_mask:0xf bank_mask:0xf
  v_dot2c_f32_bf16_dpp v214, v32, v106 row_newbcast:7 row_mask:0xf bank_mask:0xf
  v_add_f32_dpp v18, v18, v18 row_ror:1 row_mask:0xf bank_mask:0xf
  v_dot2c_f32_bf16_dpp v215, v32, v109 row_newbcast:7 row_mask:0xf bank_mask:0xf
  v_dot2c_f32_bf16_dpp v208, v32, v107 row_newbcast:8 row_mask:0xf bank_mask:0xf
  v_dot2c_f32_bf16_dpp v209, v32, v112 row_newbcast:8 row_mask:0xf bank_mask:0xf
  v_dot2c_f32_bf16_dpp v210, v32, v110 row_newbcast:8 row_mask:0xf bank_mask:0xf
  v_dot2c_f32_bf16_dpp v211, v32, v113 row_newbcast:8 row_mask:0xf bank_mask:0xf
  v_dot2c_f32_bf16_dpp v212, v32, v111 row_newbcast:8 row_mask:0xf bank_mask:0xf
  v_dot2c_f32_bf16_dpp v213, v32, v116 row_newbcast:8 row_mask:0xf bank_mask:0xf
  v_dot2c_f32_bf16_dpp v214, v32, v114 row_newbcast:8 row_mask:0xf bank_mask:0xf
  v_dot2c_f32_bf16_dpp v215, v32, v117 row_newbcast:8 row_mask:0xf bank_mask:0xf
  v_dot2c_f32_bf16_dpp v208, v32, v115 row_newbcast:9 row_mask:0xf bank_mask:0xf
  v_dot2c_f32_bf16_dpp v209, v32, v120 row_newbcast:9 row_mask:0xf bank_mask:0xf
  v_dot2c_f32_bf16_dpp v210, v32, v118 row_newbcast:9 row_mask:0xf bank_mask:0xf
  v_dot2c_f32_bf16_dpp v211, v32, v121 row_newbcast:9 row_mask:0xf bank_mask:0xf
  v_dot2c_f32_bf16_dpp v212, v32, v119 row_newbcast:9 row_mask:0xf bank_mask:0xf
  v_dot2c_f32_bf16_dpp v213, v32, v124 row_newbcast:9 row_mask:0xf bank_mask:0xf
  v_dot2c_f32_bf16_dpp v214, v32, v122 row_newbcast:9 row_mask:0xf bank_mask:0xf
  v_dot2c_f32_bf16_dpp v215, v32, v125 row_newbcast:9 row_mask:0xf bank_mask:0xf
  v_dot2c_f32_bf16_dpp v208, v32, v123 row_newbcast:10 row_mask:0xf bank_mask:0xf
  v_dot2c_f32_bf16_dpp v209, v32, v128 row_newbcast:10 row_mask:0xf bank_mask:0xf
  v_dot2c_f32_bf16_dpp v210, v32, v126 row_newbcast:10 row_mask:0xf bank_mask:0xf
  v_dot2c_f32_bf16_dpp v211, v32, v129 row_newbcast:10 row_mask:0xf bank_mask:0xf
  v_dot2c_f32_bf16_dpp v212, v32, v127 row_newbcast:10 row_mask:0xf bank_mask:0xf
  v_dot2c_f32_bf16_dpp v213, v32, v132 row_newbcast:10 row_mask:0xf bank_mask:0xf
  v_dot2c_f32_bf16_dpp v214, v32, v130 row_newbcast:10 row_mask:0xf bank_mask:0xf
  v_dot2c_f32_bf16_dpp v215, v32, v133 row_newbcast:10 row_mask:0xf bank_mask:0xf
  v_dot2c_f32_bf16_dpp v208, v32, v131 row_newbcast:11 row_mask:0xf bank_mask:0xf
  v_dot2c_f32_bf16_dpp v209, v32, v136 row_newbcast:11 row_mask:0xf bank_mask:0xf
  v_dot2c_f32_bf16_dpp v210, v32, v134 row_newbcast:11 row_mask:0xf bank_mask:0xf
  v_dot2c_f32_bf16_dpp v211, v32, v137 row_newbcast:11 row_mask:0xf bank_mask:0xf
  v_dot2c_f32_bf16_dpp v212, v32, v135 row_newbcast:11 row_mask:0xf bank_mask:0xf
  v_dot2c_f32_bf16_dpp v213, v32, v140 row_newbcast:11 row_mask:0xf bank_mask:0xf
  v_dot2c_f32_bf16_dpp v214, v32, v138 row_newbcast:11 row_mask:0xf bank_mask:0xf
  v_dot2c_f32_bf16_dpp v215, v32, v141 row_newbcast:11 row_mask:0xf bank_mask:0xf
  v_dot2c_f32_bf16_dpp v208, v32, v139 row_newbcast:12 row_mask:0xf bank_mask:0xf
  v_dot2c_f32_bf16_dpp v209, v32, v144 row_newbcast:12 row_mask:0xf bank_mask:0xf
  v_dot2c_f32_bf16_dpp v210, v32, v142 row_newbcast:12 row_mask:0xf bank_mask:0xf
  v_dot2c_f32_bf16_dpp v211, v32, v145 row_newbcast:12 row_mask:0xf bank_mask:0xf
  v_dot2c_f32_bf16_dpp v212, v32, v143 row_newbcast:12 row_mask:0xf bank_mask:0xf
  v_dot2c_f32_bf16_dpp v213, v32, v148 row_newbcast:12 row_mask:0xf bank_mask:0xf
  v_dot2c_f32_bf16_dpp v214, v32, v146 row_newbcast:12 row_mask:0xf bank_mask:0xf
  v_dot2c_f32_bf16_dpp v215, v32, v149 row_newbcast:12 row_mask:0xf bank_mask:0xf
  v_dot2c_f32_bf16_dpp v208, v32, v147 row_newbcast:13 row_mask:0xf bank_mask:0xf
  v_dot2c_f32_bf16_dpp v209, v32, v152 row_newbcast:13 row_mask:0xf bank_mask:0xf
  v_dot2c_f32_bf16_dpp v210, v32, v150 row_newbcast:13 row_mask:0xf bank_mask:0xf
  v_dot2c_f32_bf16_dpp v211, v32, v153 row_newbcast:13 row_mask:0xf bank_mask:0xf
  v_dot2c_f32_bf16_dpp v212, v32, v151 row_newbcast:13 row_mask:0xf bank_mask:0xf
  v_dot2c_f32_bf16_dpp v213, v32, v156 row_newbcast:13 row_mask:0xf bank_mask:0xf
  v_dot2c_f32_bf16_dpp v214, v32, v154 row_newbcast:13 row_mask:0xf bank_mask:0xf
  v_dot2c_f32_bf16_dpp v215, v32, v157 row_newbcast:13 row_mask:0xf bank_mask:0xf
  v_dot2c_f32_bf16_dpp v208, v32, v155 row_newbcast:14 row_mask:0xf bank_mask:0xf
  v_dot2c_f32_bf16_dpp v209, v32, v160 row_newbcast:14 row_mask:0xf bank_mask:0xf
  v_dot2c_f32_bf16_dpp v210, v32, v158 row_newbcast:14 row_mask:0xf bank_mask:0xf
  v_dot2c_f32_bf16_dpp v211, v32, v161 row_newbcast:14 row_mask:0xf bank_mask:0xf
  v_dot2c_f32_bf16_dpp v212, v32, v159 row_newbcast:14 row_mask:0xf bank_mask:0xf
  v_dot2c_f32_bf16_dpp v213, v32, v164 row_newbcast:14 row_mask:0xf bank_mask:0xf
  v_dot2c_f32_bf16_dpp v214, v32, v162 row_newbcast:14 row_mask:0xf bank_mask:0xf
  v_dot2c_f32_bf16_dpp v215, v32, v165 row_newbcast:14 row_mask:0xf bank_mask:0xf
  v_dot2c_f32_bf16_dpp v208, v32, v163 row_newbcast:15 row_mask:0xf bank_mask:0xf
  v_dot2c_f32_bf16_dpp v209, v32, v168 row_newbcast:15 row_mask:0xf bank_mask:0xf
  v_dot2c_f32_bf16_dpp v210, v32, v166 row_newbcast:15 row_mask:0xf bank_mask:0xf
  v_dot2c_f32_bf16_dpp v211, v32, v169 row_newbcast:15 row_mask:0xf bank_mask:0xf
  v_dot2c_f32_bf16_dpp v212, v32, v167 row_newbcast:15 row_mask:0xf bank_mask:0xf
  v_dot2c_f32_bf16_dpp v213, v32, v172 row_newbcast:15 row_mask:0xf bank_mask:0xf
  v_dot2c_f32_bf16_dpp v214, v32, v170 row_newbcast:15 row_mask:0xf bank_mask:0xf
  v_dot2c_f32_bf16_dpp v215, v32, v173 row_newbcast:15 row_mask:0xf bank_mask:0xf
  v_dot2c_f32_bf16_dpp v208, v33, v171 row_newbcast:0 row_mask:0xf bank_mask:0xf
  v_dot2c_f32_bf16_dpp v209, v33, v176 row_newbcast:0 row_mask:0xf bank_mask:0xf
  v_dot2c_f32_bf16_dpp v210, v33, v174 row_newbcast:0 row_mask:0xf bank_mask:0xf
  v_dot2c_f32_bf16_dpp v211, v33, v177 row_newbcast:0 row_mask:0xf bank_mask:0xf
  v_dot2c_f32_bf16_dpp v212, v33, v175 row_newbcast:0 row_mask:0xf bank_mask:0xf
  v_dot2c_f32_bf16_dpp v213, v33, v180 row_newbcast:0 row_mask:0xf bank_mask:0xf
  v_dot2c_f32_bf16_dpp v214, v33, v178 row_newbcast:0 row_mask:0xf bank_mask:0xf
  v_dot2c_f32_bf16_dpp v215, v33, v181 row_newbcast:0 row_mask:0xf bank_mask:0xf
  v_dot2c_f32_bf16_dpp v208, v33, v179 row_newbcast:1 row_mask:0xf bank_mask:0xf
  v_dot2c_f32_bf16_dpp v209, v33, v184 row_newbcast:1 row_mask:0xf bank_mask:0xf
  v_dot2c_f32_bf16_dpp v210, v33, v182 row_newbcast:1 row_mask:0xf bank_mask:0xf
  v_dot2c_f32_bf16_dpp v211, v33, v185 row_newbcast:1 row_mask:0xf bank_mask:0xf
  v_dot2c_f32_bf16_dpp v212, v33, v183 row_newbcast:1 row_mask:0xf bank_mask:0xf
  v_dot2c_f32_bf16_dpp v213, v33, v188 row_newbcast:1 row_mask:0xf bank_mask:0xf
  v_dot2c_f32_bf16_dpp v214, v33, v186 row_newbcast:1 row_mask:0xf bank_mask:0xf
  v_dot2c_f32_bf16_dpp v215, v33, v189 row_newbcast:1 row_mask:0xf bank_mask:0xf
  v_dot2c_f32_bf16_dpp v208, v33, v187 row_newbcast:2 row_mask:0xf bank_mask:0xf
  v_dot2c_f32_bf16_dpp v209, v33, v192 row_newbcast:2 row_mask:0xf bank_mask:0xf
  v_dot2c_f32_bf16_dpp v210, v33, v190 row_newbcast:2 row_mask:0xf bank_mask:0xf
  v_dot2c_f32_bf16_dpp v211, v33, v193 row_newbcast:2 row_mask:0xf bank_mask:0xf
  v_dot2c_f32_bf16_dpp v212, v33, v191 row_newbcast:2 row_mask:0xf bank_mask:0xf
  v_dot2c_f32_bf16_dpp v213, v33, v196 row_newbcast:2 row_mask:0xf bank_mask:0xf
  v_dot2c_f32_bf16_dpp v214, v33, v194 row_newbcast:2 row_mask:0xf bank_mask:0xf
  v_dot2c_f32_bf16_dpp v215, v33, v197 row_newbcast:2 row_mask:0xf bank_mask:0xf
  v_dot2c_f32_bf16_dpp v208, v33, v195 row_newbcast:3 row_mask:0xf bank_mask:0xf
  v_dot2c_f32_bf16_dpp v209, v33, v200 row_newbcast:3 row_mask:0xf bank_mask:0xf
  v_dot2c_f32_bf16_dpp v210, v33, v198 row_newbcast:3 row_mask:0xf bank_mask:0xf
  v_dot2c_f32_bf16_dpp v211, v33, v201 row_newbcast:3 row_mask:0xf bank_mask:0xf
  v_dot2c_f32_bf16_dpp v212, v33, v199 row_newbcast:3 row_mask:0xf bank_mask:0xf
  v_dot2c_f32_bf16_dpp v213, v33, v204 row_newbcast:3 row_mask:0xf bank_mask:0xf
  v_dot2c_f32_bf16_dpp v214, v33, v202 row_newbcast:3 row_mask:0xf bank_mask:0xf
  v_dot2c_f32_bf16_dpp v215, v33, v205 row_newbcast:3 row_mask:0xf bank_mask:0xf
  s_nop 0
  s_nop 1
  v_permlane32_swap_b32 v208, v210
  v_permlane32_swap_b32 v209, v211
  v_permlane32_swap_b32 v212, v214
  v_permlane32_swap_b32 v213, v215
  v_add_f32 v208, v208, v210
  v_add_f32 v209, v209, v211
  v_add_f32 v212, v212, v214
  v_add_f32 v213, v213, v215
  s_nop 0
  v_permlane16_swap_b32 v208, v209
  v_permlane16_swap_b32 v212, v213
  s_nop 0
  v_add_f32 v16, v208, v209
  v_add_f32 v17, v212, v213
  s_mov_b32 exec_lo, 1
  s_mov_b32 exec_hi, 1
  ds_write_b32 v24, v18 offset:23840
  s_mov_b64 exec, -1
  ds_write_b64 v9, v[16:17]
  s_mov_b64 exec, 1
  ds_add_rtn_u32 v12, v11, v3 offset:21780
  s_mov_b64 exec, -1
  ds_read_b128 v[28:31], v11 offset:23840
  ds_read_b128 v[36:39], v11 offset:23856
  ds_read_b64 v[16:17], v25 offset:19712
  ds_read_b64 v[18:19], v25 offset:20224
  ds_read_b64 v[20:21], v25 offset:20736
  ds_read_b64 v[22:23], v25 offset:21248
  ds_read_b64 v[208:209], v25 offset:21792
  ds_read_b64 v[210:211], v25 offset:22304
  ds_read_b64 v[212:213], v25 offset:22816
  ds_read_b64 v[214:215], v25 offset:23328
  s_waitcnt lgkmcnt(8)
  v_readfirstlane_b32 s42, v12
  s_cmp_lg_u32 s42, s47
  s_cbranch_scc1 L_gu_next
  v_pk_add_f32 v[28:29], v[28:29], v[30:31]
  v_pk_add_f32 v[36:37], v[36:37], v[38:39]
  v_pk_add_f32 v[28:29], v[28:29], v[36:37]
  v_mul_f32 v28, 0x3acccccd, v28
  v_mul_f32 v29, 0x3acccccd, v29
  v_fma_f32 v29, -v28, v28, v29
  v_add_f32 v29, 0x3727c5ac, v29
  v_rsq_f32 v29, v29
  s_waitcnt lgkmcnt(0)
  v_pk_add_f32 v[16:17], v[16:17], v[18:19]
  v_pk_add_f32 v[20:21], v[20:21], v[22:23]
  v_pk_add_f32 v[208:209], v[208:209], v[210:211]
  v_pk_add_f32 v[212:213], v[212:213], v[214:215]
  v_pk_add_f32 v[16:17], v[16:17], v[20:21]
  v_pk_add_f32 v[208:209], v[208:209], v[212:213]
  v_fma_f32 v16, -v28, v208, v16
  v_fma_f32 v17, -v28, v209, v17
  v_mul_f32 v16, v16, v29
  v_mul_f32 v17, v17, v29
  v_cvt_pk_bf16_f32 v16, v16, v16
  v_and_b32 v16, 0xffff0000, v16
  v_mul_f32 v18, 0xbfb8aa3b, v16
  v_exp_f32 v18, v18
  v_cvt_pk_bf16_f32 v17, v17, v17
  v_and_b32 v17, 0xffff0000, v17
  v_add_f32 v18, 1.0, v18
  v_rcp_f32 v18, v18
  s_nop 0
  v_cvt_pk_bf16_f32 v18, v18, v18
  v_and_b32 v18, 0xffff0000, v18
  v_mul_f32 v18, v18, v17
  s_nop 1
  v_mov_b32_dpp v19, v18 quad_perm:[1,0,3,2] row_mask:0xf bank_mask:0xf
  v_cvt_pk_bf16_f32 v18, v18, v19
  s_nop 1
  v_mov_b32_dpp v19, v18 quad_perm:[0,0,2,2] row_mask:0xf bank_mask:0xf
  s_cmp_eq_u32 s53, 0
  s_cbranch_scc1 L_hps_far
  buffer_store_dword v19, v6, s[4:7], 0 offen
L_hps_done:
L_gu_next:
  s_cmp_lg_u32 s49, 0
  s_cbranch_scc1 L_fin
L_gu_real:
  s_mov_b32 s49, 1
  s_mov_b32 s47, 3
  v_mov_b32 v3, 1
  v_mov_b32 v208, 0
  v_mov_b32 v209, 0
  v_mov_b32 v210, 0
  v_mov_b32 v211, 0
  v_mov_b32 v212, 0
  v_mov_b32 v213, 0
  v_mov_b32 v214, 0
  v_mov_b32 v215, 0
  s_mov_b32 s58, 20000
L_hs_gu:
  global_load_dword v13, v11, s[36:37] sc1
  s_waitcnt vmcnt(0)
  v_and_b32 v12, 63, v13
  v_cmp_gt_u32 vcc, 32, v12
  s_cbranch_vccz L_hs_gu_ok
  s_sleep 32
  s_sub_u32 s58, s58, 1
  s_cbranch_scc0 L_hs_gu
L_hs_gu_ok:
  s_getreg_b32 s42, hwreg(HW_REG_XCC_ID, 0, 4)
  s_mul_i32 s43, s42, s42
  s_lshl_b32 s43, s43, 15
  s_lshl_b32 s42, s42, 6
  s_add_u32 s42, s42, s43
  s_add_u32 s42, s42, 1
  s_lshl_b32 s42, s42, 5
  v_readfirstlane_b32 s43, v13
  s_cmp_eq_u32 s42, s43
  s_cselect_b32 s53, 1, 0
  v_mov_b32 v13, s59
  s_add_u32 s42, s53, 1
  v_mov_b32 v14, s42
  v_mov_b32 v12, 1
  s_mov_b64 exec, 1
  ds_write_b32 v11, v13 offset:21760
  ds_write_b32 v11, v14 offset:21776
  ds_add_u32 v11, v12 offset:21788
  s_mov_b64 exec, -1
  s_mov_b32 s58, 20000
L_pw_gu:
  ds_read_b32 v12, v11 offset:21768
  s_waitcnt lgkmcnt(0)
  v_cmp_ne_u32 vcc, 0, v12
  s_cbranch_vccnz L_pw_gu_ok
  s_sleep 2
  s_sub_u32 s58, s58, 1
  s_cbranch_scc0 L_pw_gu
L_pw_gu_ok:
  s_setprio 3
  s_mov_b32 s58, 20000
  s_branch L_gu_top
L_tail:
  s_waitcnt vmcnt(0)
  v_mov_b32 v11, 0
  v_mov_b32 v3, 1
  s_mov_b32 s47, 3
  s_mov_b32 s49, 1
  s_mov_b32 s46, 80000
  s_mov_b32 s51, 0xffff0000
  s_mov_b32 s4, s38
  s_mov_b32 s5, s39
  s_mov_b32 s6, 1441792
  s_mov_b32 s7, 0x20000
  s_add_u32 s54, s60, 8
  s_cmp_lt_u32 s60, 12
  s_cselect_b32 s54, s54, 0xffff
  s_sub_u32 s42, s60, 24
  s_cmp_ge_u32 s60, 24
  s_cselect_b32 s54, s42, s54
  s_cmp_eq_u32 s61, 0
  s_cselect_b32 s54, s54, 0xffff
  s_lshl_b32 s55, s3, 5
  s_add_u32 s55, s55, s60
  s_mov_b32 s8, s16
  s_mov_b32 s9, s17
  s_mov_b32 s10, 1280
  s_mov_b32 s11, 0x20000
  v_and_b32 v14, 1, v2
  v_lshrrev_b32 v15, 5, v2
  v_lshlrev_b32 v20, 3, v14
  v_lshl_add_u32 v20, v15, 2, v20
  s_min_u32 s42, s55, 79
  s_lshl_b32 s42, s42, 4
  buffer_load_dword v21, v20, s[8:11], s42 offen
  v_lshl_add_u32 v22, v14, 1, v15
  s_add_u32 s42, s42, 950272
  v_lshl_add_u32 v22, v22, 2, s42
  s_lshl_b32 s42, s55, 10
  s_add_u32 s42, s42, 1114112
  v_lshl_add_u32 v23, v2, 4, s42
  s_mov_b32 s58, 20000
L_dw:
  ds_read_b32 v12, v11 offset:21788
  ds_read_b32 v13, v11 offset:21760
  ds_read_b32 v14, v11 offset:21776
  s_waitcnt lgkmcnt(0)
  v_cmp_eq_u32 vcc, 4, v12
  s_cbranch_vccnz L_dw_ok
  s_sleep 2
  s_sub_u32 s58, s58, 1
  s_cbranch_scc0 L_dw
L_dw_ok:
  v_readfirstlane_b32 s59, v13
  v_readfirstlane_b32 s53, v14
  s_sub_u32 s53, s53, 1
  s_waitcnt vmcnt(0)
  v_lshlrev_b32 v20, 16, v21
  v_and_b32 v21, s51, v21
  s_cmp_eq_u32 s54, 0xffff
  s_cbranch_scc1 L_red
  s_mul_i32 s42, s3, 24576
  s_add_u32 s42, s42, 28480
  v_lshl_add_u32 v17, v2, 4, s42
  ds_read_b128 v[48:51], v17 offset:0
  ds_read_b128 v[52:55], v17 offset:1024
  ds_read_b128 v[56:59], v17 offset:2048
  ds_read_b128 v[60:63], v17 offset:3072
  ds_read_b128 v[64:67], v17 offset:4096
  ds_read_b128 v[68:71], v17 offset:5120
  ds_read_b128 v[72:75], v17 offset:6144
  ds_read_b128 v[76:79], v17 offset:7168
  ds_read_b128 v[80:83], v17 offset:8192
  ds_read_b128 v[84:87], v17 offset:9216
  ds_read_b128 v[88:91], v17 offset:10240
  ds_read_b128 v[92:95], v17 offset:11264
  ds_read_b128 v[96:99], v17 offset:12288
  ds_read_b128 v[100:103], v17 offset:13312
  ds_read_b128 v[104:107], v17 offset:14336
  ds_read_b128 v[108:111], v17 offset:15360
  ds_read_b128 v[112:115], v17 offset:16384
  ds_read_b128 v[116:119], v17 offset:17408
  ds_read_b128 v[120:123], v17 offset:18432
  ds_read_b128 v[124:127], v17 offset:19456
  ds_read_b128 v[128:131], v17 offset:20480
  ds_read_b128 v[132:135], v17 offset:21504
  ds_read_b128 v[136:139], v17 offset:22528
  ds_read_b128 v[140:143], v17 offset:23552
  s_waitcnt lgkmcnt(0)
L_red:
  s_cmp_ge_u32 s55, 80
  s_cbranch_scc1 L_red_done
  s_mov_b32 s58, s46
L_h2:
  buffer_load_dwordx4 v[24:27], v23, s[4:7], 0 offen sc1
  s_waitcnt vmcnt(0)
  v_max3_u32 v12, v24, v25, v26
  v_max_u32 v12, v12, v27
  v_cmp_eq_u32 vcc, -1, v12
  s_cbranch_vccz L_h2_ok
  s_sub_u32 s58, s58, 1
  s_cbranch_scc0 L_h2
L_h2_ok:
  v_permlane32_swap_b32 v24, v26
  v_permlane32_swap_b32 v25, v27
  s_nop 0
  v_add_f32 v24, v24, v26
  v_add_f32 v25, v25, v27
  v_mov_b32 v26, v24
  v_mov_b32 v27, v25
  s_nop 0
  v_permlane16_swap_b32 v24, v26
  v_permlane16_swap_b32 v25, v27
  s_nop 0
  v_add_f32 v24, v24, v26
  v_add_f32 v25, v25, v27
  s_nop 0
  v_add_f32_dpp v24, v24, v24 row_ror:8 row_mask:0xf bank_mask:0xf
  v_add_f32_dpp v25, v25, v25 row_ror:8 row_mask:0xf bank_mask:0xf
  s_nop 0
  v_add_f32_dpp v24, v24, v24 row_ror:4 row_mask:0xf bank_mask:0xf
  v_add_f32_dpp v25, v25, v25 row_ror:4 row_mask:0xf bank_mask:0xf
  s_nop 0
  v_add_f32_dpp v24, v24, v24 row_ror:2 row_mask:0xf bank_mask:0xf
  v_add_f32_dpp v25, v25, v25 row_ror:2 row_mask:0xf bank_mask:0xf
  v_cvt_pk_bf16_f32 v26, v24, v25
  v_lshlrev_b32 v24, 16, v26
  v_and_b32 v25, s51, v26
  v_add_f32 v24, v24, v20
  v_add_f32 v25, v25, v21
  v_cvt_pk_bf16_f32 v26, v24, v25
  s_mov_b32 exec_lo, 3
  s_mov_b32 exec_hi, 3
  s_cmp_eq_u32 s53, 0
  s_cbranch_scc1 L_hst_far
  buffer_store_dword v26, v22, s[4:7], 0 offen
L_hst_done:
  s_mov_b64 exec, -1
L_red_done:
  s_cmp_eq_u32 s54, 0xffff
  s_cbranch_scc1 L_dn_fin
  s_and_b32 s42, s54, 1
  s_mul_i32 s42, s42, 3328
  s_mul_i32 s43, s3, 768
  s_add_u32 s42, s42, s43
  s_add_u32 s42, s42, 1015808
  v_mul_u32_u24 v14, 12, v2
  v_add_u32 v6, s42, v14
  v_and_b32 v14, 3, v2
  v_lshlrev_b32 v14, 3, v14
  v_bfe_u32 v15, v2, 5, 1
  v_lshl_add_u32 v14, v15, 2, v14
  v_bfe_u32 v15, v2, 4, 1
  v_lshl_add_u32 v14, v15, 1, v14
  v_bfe_u32 v15, v2, 3, 1
  v_add_u32 v14, v14, v15
  s_lshl_b32 s42, s3, 7
  s_add_u32 s42, s42, 27968
  v_lshlrev_b32 v14, 2, v14
  v_add_u32 v7, s42, v14
  s_lshl_b32 s42, s54, 6
  s_add_u32 s42, s42, 950272
  v_bfe_u32 v14, v2, 1, 4
  v_lshlrev_b32 v14, 2, v14
  v_add_u32 v8, s42, v14
  v_and_b32 v14, 1, v2
  v_lshlrev_b32 v14, 4, v14
  v_sub_u32 v9, 16, v14
  v_mov_b32 v32, 0
  v_mov_b32 v33, 0
  v_mov_b32 v34, 0
  v_mov_b32 v35, 0
  v_mov_b32 v36, 0
  v_mov_b32 v37, 0
  v_mov_b32 v38, 0
  v_mov_b32 v39, 0
  v_and_b32 v13, 31, v2
  v_lshlrev_b32 v13, 2, v13
  s_mov_b32 s8, s34
  s_mov_b32 s9, s35
  s_mov_b32 s10, 1280
  s_mov_b32 s11, 0x20000
  s_lshl_b32 s43, s54, 6
  v_lshlrev_b32 v14, 1, v2
  s_waitcnt lgkmcnt(0)
  s_cmp_ge_u32 s60, 24
  s_cbranch_scc1 L_dg_ok
  s_cmp_eq_u32 s49, 0
  s_cbranch_scc1 L_dg_ok
  s_mov_b32 s58, 80000
L_dg:
  ds_read_b32 v12, v11 offset:21780
  s_waitcnt lgkmcnt(0)
  v_cmp_ne_u32 vcc, 0, v12
  s_cbranch_vccnz L_dg_ok
  s_sleep 2
  s_sub_u32 s58, s58, 1
  s_cbranch_scc0 L_dg
L_dg_ok:
  s_mov_b32 s58, s46
L_h4:
  buffer_load_dwordx3 v[16:18], v6, s[4:7], 0 offen sc1
  buffer_load_dword v28, v8, s[4:7], 0 offen sc1
  s_waitcnt vmcnt(0)
  v_max3_u32 v19, v16, v17, v18
  v_max_u32 v19, v19, v28
  v_cmp_eq_u32 vcc, -1, v19
  s_cbranch_vccz L_h4_ok
  s_sub_u32 s58, s58, 1
  s_cbranch_scc0 L_h4
L_h4_ok:
  v_dot2c_f32_bf16_dpp v32, v16, v48 quad_perm:[0,0,0,0] row_mask:0xf bank_mask:0xf
  v_dot2c_f32_bf16_dpp v33, v16, v49 quad_perm:[0,0,0,0] row_mask:0xf bank_mask:0xf
  v_dot2c_f32_bf16_dpp v34, v16, v50 quad_perm:[0,0,0,0] row_mask:0xf bank_mask:0xf
  v_dot2c_f32_bf16_dpp v35, v16, v51 quad_perm:[0,0,0,0] row_mask:0xf bank_mask:0xf
  v_dot2c_f32_bf16_dpp v36, v16, v52 quad_perm:[0,0,0,0] row_mask:0xf bank_mask:0xf
  v_dot2c_f32_bf16_dpp v37, v16, v53 quad_perm:[0,0,0,0] row_mask:0xf bank_mask:0xf
  v_dot2c_f32_bf16_dpp v38, v16, v54 quad_perm:[0,0,0,0] row_mask:0xf bank_mask:0xf
  v_dot2c_f32_bf16_dpp v39, v16, v55 quad_perm:[0,0,0,0] row_mask:0xf bank_mask:0xf
  v_dot2c_f32_bf16_dpp v32, v17, v56 quad_perm:[0,0,0,0] row_mask:0xf bank_mask:0xf
  v_dot2c_f32_bf16_dpp v33, v17, v57 quad_perm:[0,0,0,0] row_mask:0xf bank_mask:0xf
  v_dot2c_f32_bf16_dpp v34, v17, v58 quad_perm:[0,0,0,0] row_mask:0xf bank_mask:0xf
  v_dot2c_f32_bf16_dpp v35, v17, v59 quad_perm:[0,0,0,0] row_mask:0xf bank_mask:0xf
  v_dot2c_f32_bf16_dpp v36, v17, v60 quad_perm:[0,0,0,0] row_mask:0xf bank_mask:0xf
  v_dot2c_f32_bf16_dpp v37, v17, v61 quad_perm:[0,0,0,0] row_mask:0xf bank_mask:0xf
  v_dot2c_f32_bf16_dpp v38, v17, v62 quad_perm:[0,0,0,0] row_mask:0xf bank_mask:0xf
  v_dot2c_f32_bf16_dpp v39, v17, v63 quad_perm:[0,0,0,0] row_mask:0xf bank_mask:0xf
  v_dot2c_f32_bf16_dpp v32, v18, v64 quad_perm:[0,0,0,0] row_mask:0xf bank_mask:0xf
  v_dot2c_f32_bf16_dpp v33, v18, v65 quad_perm:[0,0,0,0] row_mask:0xf bank_mask:0xf
  v_dot2c_f32_bf16_dpp v34, v18, v66 quad_perm:[0,0,0,0] row_mask:0xf bank_mask:0xf
  v_dot2c_f32_bf16_dpp v35, v18, v67 quad_perm:[0,0,0,0] row_mask:0xf bank_mask:0xf
  v_dot2c_f32_bf16_dpp v36, v18, v68 quad_perm:[0,0,0,0] row_mask:0xf bank_mask:0xf
  v_dot2c_f32_bf16_dpp v37, v18, v69 quad_perm:[0,0,0,0] row_mask:0xf bank_mask:0xf
  v_dot2c_f32_bf16_dpp v38, v18, v70 quad_perm:[0,0,0,0] row_mask:0xf bank_mask:0xf
  v_dot2c_f32_bf16_dpp v39, v18, v71 quad_perm:[0,0,0,0] row_mask:0xf bank_mask:0xf
  v_dot2c_f32_bf16_dpp v32, v16, v72 quad_perm:[1,1,1,1] row_mask:0xf bank_mask:0xf
  v_dot2c_f32_bf16_dpp v33, v16, v73 quad_perm:[1,1,1,1] row_mask:0xf bank_mask:0xf
  v_dot2c_f32_bf16_dpp v34, v16, v74 quad_perm:[1,1,1,1] row_mask:0xf bank_mask:0xf
  v_dot2c_f32_bf16_dpp v35, v16, v75 quad_perm:[1,1,1,1] row_mask:0xf bank_mask:0xf
  v_dot2c_f32_bf16_dpp v36, v16, v76 quad_perm:[1,1,1,1] row_mask:0xf bank_mask:0xf
  v_dot2c_f32_bf16_dpp v37, v16, v77 quad_perm:[1,1,1,1] row_mask:0xf bank_mask:0xf
  v_dot2c_f32_bf16_dpp v38, v16, v78 quad_perm:[1,1,1,1] row_mask:0xf bank_mask:0xf
  v_dot2c_f32_bf16_dpp v39, v16, v79 quad_perm:[1,1,1,1] row_mask:0xf bank_mask:0xf
  v_dot2c_f32_bf16_dpp v32, v17, v80 quad_perm:[1,1,1,1] row_mask:0xf bank_mask:0xf
  v_dot2c_f32_bf16_dpp v33, v17, v81 quad_perm:[1,1,1,1] row_mask:0xf bank_mask:0xf
  v_dot2c_f32_bf16_dpp v34, v17, v82 quad_perm:[1,1,1,1] row_mask:0xf bank_mask:0xf
  v_dot2c_f32_bf16_dpp v35, v17, v83 quad_perm:[1,1,1,1] row_mask:0xf bank_mask:0xf
  v_dot2c_f32_bf16_dpp v36, v17, v84 quad_perm:[1,1,1,1] row_mask:0xf bank_mask:0xf
  v_dot2c_f32_bf16_dpp v37, v17, v85 quad_perm:[1,1,1,1] row_mask:0xf bank_mask:0xf
  v_dot2c_f32_bf16_dpp v38, v17, v86 quad_perm:[1,1,1,1] row_mask:0xf bank_mask:0xf
  v_dot2c_f32_bf16_dpp v39, v17, v87 quad_perm:[1,1,1,1] row_mask:0xf bank_mask:0xf
  v_dot2c_f32_bf16_dpp v32, v18, v88 quad_perm:[1,1,1,1] row_mask:0xf bank_mask:0xf
  v_dot2c_f32_bf16_dpp v33, v18, v89 quad_perm:[1,1,1,1] row_mask:0xf bank_mask:0xf
  v_dot2c_f32_bf16_dpp v34, v18, v90 quad_perm:[1,1,1,1] row_mask:0xf bank_mask:0xf
  v_dot2c_f32_bf16_dpp v35, v18, v91 quad_perm:[1,1,1,1] row_mask:0xf bank_mask:0xf
  v_dot2c_f32_bf16_dpp v36, v18, v92 quad_perm:[1,1,1,1] row_mask:0xf bank_mask:0xf
  v_dot2c_f32_bf16_dpp v37, v18, v93 quad_perm:[1,1,1,1] row_mask:0xf bank_mask:0xf
  v_dot2c_f32_bf16_dpp v38, v18, v94 quad_perm:[1,1,1,1] row_mask:0xf bank_mask:0xf
  v_dot2c_f32_bf16_dpp v39, v18, v95 quad_perm:[1,1,1,1] row_mask:0xf bank_mask:0xf
  v_dot2c_f32_bf16_dpp v32, v16, v96 quad_perm:[2,2,2,2] row_mask:0xf bank_mask:0xf
  v_dot2c_f32_bf16_dpp v33, v16, v97 quad_perm:[2,2,2,2] row_mask:0xf bank_mask:0xf
  v_dot2c_f32_bf16_dpp v34, v16, v98 quad_perm:[2,2,2,2] row_mask:0xf bank_mask:0xf
  v_dot2c_f32_bf16_dpp v35, v16, v99 quad_perm:[2,2,2,2] row_mask:0xf bank_mask:0xf
  v_dot2c_f32_bf16_dpp v36, v16, v100 quad_perm:[2,2,2,2] row_mask:0xf bank_mask:0xf
  v_dot2c_f32_bf16_dpp v37, v16, v101 quad_perm:[2,2,2,2] row_mask:0xf bank_mask:0xf
  v_dot2c_f32_bf16_dpp v38, v16, v102 quad_perm:[2,2,2,2] row_mask:0xf bank_mask:0xf
  v_dot2c_f32_bf16_dpp v39, v16, v103 quad_perm:[2,2,2,2] row_mask:0xf bank_mask:0xf
  v_dot2c_f32_bf16_dpp v32, v17, v104 quad_perm:[2,2,2,2] row_mask:0xf bank_mask:0xf
  v_dot2c_f32_bf16_dpp v33, v17, v105 quad_perm:[2,2,2,2] row_mask:0xf bank_mask:0xf
  v_dot2c_f32_bf16_dpp v34, v17, v106 quad_perm:[2,2,2,2] row_mask:0xf bank_mask:0xf
  v_dot2c_f32_bf16_dpp v35, v17, v107 quad_perm:[2,2,2,2] row_mask:0xf bank_mask:0xf
  v_dot2c_f32_bf16_dpp v36, v17, v108 quad_perm:[2,2,2,2] row_mask:0xf bank_mask:0xf
  v_dot2c_f32_bf16_dpp v37, v17, v109 quad_perm:[2,2,2,2] row_mask:0xf bank_mask:0xf
  v_dot2c_f32_bf16_dpp v38, v17, v110 quad_perm:[2,2,2,2] row_mask:0xf bank_mask:0xf
  v_dot2c_f32_bf16_dpp v39, v17, v111 quad_perm:[2,2,2,2] row_mask:0xf bank_mask:0xf
  v_dot2c_f32_bf16_dpp v32, v18, v112 quad_perm:[2,2,2,2] row_mask:0xf bank_mask:0xf
  v_dot2c_f32_bf16_dpp v33, v18, v113 quad_perm:[2,2,2,2] row_mask:0xf bank_mask:0xf
  v_dot2c_f32_bf16_dpp v34, v18, v114 quad_perm:[2,2,2,2] row_mask:0xf bank_mask:0xf
  v_dot2c_f32_bf16_dpp v35, v18, v115 quad_perm:[2,2,2,2] row_mask:0xf bank_mask:0xf
  v_dot2c_f32_bf16_dpp v36, v18, v116 quad_perm:[2,2,2,2] row_mask:0xf bank_mask:0xf
  v_dot2c_f32_bf16_dpp v37, v18, v117 quad_perm:[2,2,2,2] row_mask:0xf bank_mask:0xf
  v_dot2c_f32_bf16_dpp v38, v18, v118 quad_perm:[2,2,2,2] row_mask:0xf bank_mask:0xf
  v_dot2c_f32_bf16_dpp v39, v18, v119 quad_perm:[2,2,2,2] row_mask:0xf bank_mask:0xf
  v_dot2c_f32_bf16_dpp v32, v16, v120 quad_perm:[3,3,3,3] row_mask:0xf bank_mask:0xf
  v_dot2c_f32_bf16_dpp v33, v16, v121 quad_perm:[3,3,3,3] row_mask:0xf bank_mask:0xf
  v_dot2c_f32_bf16_dpp v34, v16, v122 quad_perm:[3,3,3,3] row_mask:0xf bank_mask:0xf
  v_dot2c_f32_bf16_dpp v35, v16, v123 quad_perm:[3,3,3,3] row_mask:0xf bank_mask:0xf
  v_dot2c_f32_bf16_dpp v36, v16, v124 quad_perm:[3,3,3,3] row_mask:0xf bank_mask:0xf
  v_dot2c_f32_bf16_dpp v37, v16, v125 quad_perm:[3,3,3,3] row_mask:0xf bank_mask:0xf
  v_dot2c_f32_bf16_dpp v38, v16, v126 quad_perm:[3,3,3,3] row_mask:0xf bank_mask:0xf
  v_dot2c_f32_bf16_dpp v39, v16, v127 quad_perm:[3,3,3,3] row_mask:0xf bank_mask:0xf
  v_dot2c_f32_bf16_dpp v32, v17, v128 quad_perm:[3,3,3,3] row_mask:0xf bank_mask:0xf
  v_dot2c_f32_bf16_dpp v33, v17, v129 quad_perm:[3,3,3,3] row_mask:0xf bank_mask:0xf
  v_dot2c_f32_bf16_dpp v34, v17, v130 quad_perm:[3,3,3,3] row_mask:0xf bank_mask:0xf
  v_dot2c_f32_bf16_dpp v35, v17, v131 quad_perm:[3,3,3,3] row_mask:0xf bank_mask:0xf
  v_dot2c_f32_bf16_dpp v36, v17, v132 quad_perm:[3,3,3,3] row_mask:0xf bank_mask:0xf
  v_dot2c_f32_bf16_dpp v37, v17, v133 quad_perm:[3,3,3,3] row_mask:0xf bank_mask:0xf
  v_dot2c_f32_bf16_dpp v38, v17, v134 quad_perm:[3,3,3,3] row_mask:0xf bank_mask:0xf
  v_dot2c_f32_bf16_dpp v39, v17, v135 quad_perm:[3,3,3,3] row_mask:0xf bank_mask:0xf
  v_dot2c_f32_bf16_dpp v32, v18, v136 quad_perm:[3,3,3,3] row_mask:0xf bank_mask:0xf
  v_dot2c_f32_bf16_dpp v33, v18, v137 quad_perm:[3,3,3,3] row_mask:0xf bank_mask:0xf
  v_dot2c_f32_bf16_dpp v34, v18, v138 quad_perm:[3,3,3,3] row_mask:0xf bank_mask:0xf
  v_dot2c_f32_bf16_dpp v35, v18, v139 quad_perm:[3,3,3,3] row_mask:0xf bank_mask:0xf
  v_dot2c_f32_bf16_dpp v36, v18, v140 quad_perm:[3,3,3,3] row_mask:0xf bank_mask:0xf
  v_dot2c_f32_bf16_dpp v37, v18, v141 quad_perm:[3,3,3,3] row_mask:0xf bank_mask:0xf
  v_dot2c_f32_bf16_dpp v38, v18, v142 quad_perm:[3,3,3,3] row_mask:0xf bank_mask:0xf
  v_dot2c_f32_bf16_dpp v39, v18, v143 quad_perm:[3,3,3,3] row_mask:0xf bank_mask:0xf
  v_lshlrev_b32 v28, v9, v28
  v_and_b32 v28, s51, v28
  s_nop 0
  v_permlane32_swap_b32 v32, v36
  v_permlane32_swap_b32 v33, v37
  v_permlane32_swap_b32 v34, v38
  v_permlane32_swap_b32 v35, v39
  v_add_f32 v32, v32, v36
  v_add_f32 v33, v33, v37
  v_add_f32 v34, v34, v38
  v_add_f32 v35, v35, v39
  s_nop 0
  v_permlane16_swap_b32 v32, v34
  v_permlane16_swap_b32 v33, v35
  v_add_f32 v32, v32, v34
  v_add_f32 v33, v33, v35
  s_nop 0
  v_add_f32_dpp v34, v32, v32 row_ror:8 row_mask:0xf bank_mask:0x3
  s_nop 1
  v_add_f32_dpp v34, v33, v33 row_ror:8 row_mask:0xf bank_mask:0xc
  s_nop 1
  v_add_f32_dpp v35, v34, v34 row_shl:4 row_mask:0xf bank_mask:0x5
  s_nop 1
  v_add_f32_dpp v35, v34, v34 row_shr:4 row_mask:0xf bank_mask:0xa
  ds_write_b32 v7, v35
  s_mov_b64 exec, 1
  ds_add_rtn_u32 v12, v11, v3 offset:21772
  s_mov_b64 exec, -1
  ds_read_b32 v16, v13 offset:27968
  ds_read_b32 v17, v13 offset:28096
  ds_read_b32 v18, v13 offset:28224
  ds_read_b32 v19, v13 offset:28352
  s_waitcnt lgkmcnt(0)
  v_readfirstlane_b32 s42, v12
  s_cmp_lg_u32 s42, s47
  s_cbranch_scc1 L_dn_fin
  v_add_f32 v16, v16, v17
  v_add_f32 v18, v18, v19
  v_add_f32 v16, v16, v18
  v_cvt_pk_bf16_f32 v16, v16, v16
  v_and_b32 v16, 0xffff0000, v16
  v_add_f32 v16, v16, v28
  s_nop 1
  v_mov_b32_dpp v17, v16 quad_perm:[1,0,3,2] row_mask:0xf bank_mask:0xf
  v_cvt_pk_bf16_f32 v16, v16, v17
  s_cmp_eq_u32 s49, 0
  s_cbranch_scc1 L_dn_fin
  s_mov_b32 s44, 0x55555555
  s_mov_b32 s45, 0
  s_mov_b64 exec, s[44:45]
  buffer_store_dword v16, v14, s[8:11], s43 offen
  s_mov_b64 exec, -1
  s_cmp_lg_u32 s54, 0
  s_cbranch_scc1 L_dn_fin
  v_mov_b32 v12, 61440
  v_mov_b32 v13, s59
  s_mov_b64 exec, 1
  buffer_store_dword v13, v12, s[4:7], 0 offen sc1
  s_mov_b64 exec, -1
L_dn_fin:
  s_cmp_eq_u32 s49, 0
  s_cbranch_scc1 L_disp3
  s_endpgm
L_hps_far:
  s_cmp_eq_u32 s49, 0
  s_cbranch_scc1 L_hps_done
  buffer_store_dword v19, v6, s[4:7], 0 offen sc1
  s_branch L_hps_done
L_hst_far:
  s_cmp_eq_u32 s49, 0
  s_cbranch_scc1 L_hst_done
  buffer_store_dword v26, v22, s[4:7], 0 offen sc1
  s_branch L_hst_done
L_fin:
  s_waitcnt lgkmcnt(0)
L_end:
  s_endpgm
.section .rodata,"a"
.p2align 6
.amdhsa_kernel sequential_preLN__mha_block_cached__glu_gated_glu__decode_kernel
  .amdhsa_next_free_vgpr 256
  .amdhsa_next_free_sgpr 102
  .amdhsa_accum_offset 256
  .amdhsa_group_segment_fixed_size 0
  .amdhsa_kernarg_size 96
  .amdhsa_user_sgpr_count 2
  .amdhsa_user_sgpr_kernarg_segment_ptr 1
  .amdhsa_system_sgpr_workgroup_id_x 1
.end_amdhsa_kernel
```
